```python
import torch

def _softmax(x, axis=-1):
    return torch.softmax(x, dim=axis)
def _gelu(x):
    return torch.nn.functional.gelu(x, approximate="tanh")
def _silu(x):
    return torch.nn.functional.silu(x)
def _sigmoid(x):
    return torch.sigmoid(x)
def _layernorm(x, axis=-1, eps=1e-5):
    m = x.mean(dim=axis, keepdim=True)
    v = x.var(dim=axis, keepdim=True, unbiased=False)
    return (x - m) / torch.sqrt(v + eps)
def _scatter_add(tgt, idx, src, axis=0):
    return tgt.clone().index_add_(axis, idx, src)
def _segment_sum(src, seg, n):
    out = torch.zeros((n,) + src.shape[1:], dtype=src.dtype)
    return out.index_add_(0, seg, src)
def _pad(x, pw):
    flat = tuple(v for pair in reversed(pw) for v in pair)
    return torch.nn.functional.pad(x, flat)

kernel_name = 'parallel_sum__softmax_full_mha__dense_activation_squared_relu__prompt'

def setup_inputs():

    _w = (lambda a: (lambda t: t.to(torch.bfloat16) if t.is_floating_point() else t)(torch.as_tensor(a)))
    def _A_setup():
        B, S, D = 1, 2048, 512
        return {
            "x": _w((lambda *s: torch.randn(*s, dtype=torch.bfloat16) * 0.05)(B, S, D)),
            "wqkv": _w((lambda *s: torch.randn(*s, dtype=torch.bfloat16) * 0.2)(D, 3 * D)),
            "wo": _w((lambda *s: torch.randn(*s, dtype=torch.bfloat16) * 0.1)(D, D)),
        }
    _A_in = _A_setup()

    def _B_setup():
        B, S, D, F = 1, 2048, 512, 1376
        return {
            "x": _w((lambda *s: torch.randn(*s, dtype=torch.bfloat16) * 0.05)(B, S, D)),
            "w1": _w((lambda *s: torch.randn(*s, dtype=torch.bfloat16) * 0.1)(D, F)),
            "b1": _w((lambda *s: torch.randn(*s, dtype=torch.bfloat16) * 0.8)(F)),
            "w2": _w((lambda *s: torch.randn(*s, dtype=torch.bfloat16) * 0.1)(F, D)),
            "b2": _w((lambda *s: torch.randn(*s, dtype=torch.bfloat16) * 12.8)(D)),
        }
    _B_in = _B_setup()

    return {
        "A_x": _A_in["x"],
        "A_wqkv": _A_in["wqkv"],
        "A_wo": _A_in["wo"],
        "B_x": _B_in["x"],
        "B_w1": _B_in["w1"],
        "B_b1": _B_in["b1"],
        "B_w2": _B_in["w2"],
        "B_b2": _B_in["b2"],
    }

def reference(A_x, A_wqkv, A_wo, B_x, B_w1, B_b1, B_w2, B_b2):
    def _A_ref(x, wqkv, wo):
        B, S, D = x.shape
        H = 32; Dh = D // H
        qkv = (lambda x, *d: x.permute(*d))((x @ wqkv).reshape(B, S, 3, H, Dh), 2, 0, 3, 1, 4)
        q, k, v = qkv[0], qkv[1], qkv[2]
        scale = Dh ** -0.5
        scores = torch.einsum("bhqd,bhkd->bhqk", q, k) * scale
        p = _softmax(scores, axis=-1)
        o = torch.einsum("bhqk,bhkd->bhqd", p, v)
        return (lambda x, *d: x.permute(*d))(o, 0, 2, 1, 3).reshape(B, S, D) @ wo

    def _B_ref(x, w1, b1, w2, b2):
        h = torch.einsum("bsd,df->bsf", x, w1) + b1
        zero = torch.zeros_like(h)
        r = torch.where(h > zero, h, zero)
        h = r * r
        out = torch.einsum("bsf,fd->bsd", h, w2) + b2
        return out

    x = A_x
    xn = _layernorm(x, axis=-1)
    return x + _A_ref(xn, A_wqkv, A_wo) + _B_ref(xn, B_w1, B_b1, B_w2, B_b2)
```

```asm
; @launch grid=(256,1,1) block=(512,1,1) lds=163840
.amdgcn_target "amdgcn-amd-amdhsa--gfx950"
.text
.globl parallel_sum__softmax_full_mha__dense_activation_squared_relu__prompt_kernel
.p2align 12
.fill 832, 4, 0xbf800000
.p2align 8
.type parallel_sum__softmax_full_mha__dense_activation_squared_relu__prompt_kernel,@function
parallel_sum__softmax_full_mha__dense_activation_squared_relu__prompt_kernel:
    s_cmpk_ge_u32 s2, 256
    s_cbranch_scc1 L_exit
    s_load_dwordx2 s[36:37], s[0:1], 0
    s_load_dwordx2 s[40:41], s[0:1], 8
    s_load_dwordx2 s[52:53], s[0:1], 80
    v_readfirstlane_b32 s5, v0
    v_lshrrev_b32 v84, 4, v0
    s_lshr_b32 s4, s2, 5
    v_lshrrev_b32 v46, 3, v0
    s_bfe_u32 s3, s2, 0x40001
    v_xor_b32 v85, v84, v0
    s_mul_i32 s8, s4, 2
    v_and_b32 v85, 7, v85
    s_add_u32 s8, s8, s2
    v_lshl_or_b32 v85, v46, 6, v85
    s_bfe_u32 s10, s2, 0x20003
    s_mul_i32 s10, s10, 4
    s_add_u32 s8, s8, s10
    s_lshl_b32 s11, s3, 17
    s_and_b32 s8, s8, 7
    v_lshl_add_u32 v10, v85, 4, s11
    s_lshl_b32 s24, s8, 7
    v_and_b32 v93, 1, v84
    s_lshl_b32 s80, s5, 4
    v_add_u32 v45, 65536, v10
    s_mov_b32 s38, 2097152
    v_lshlrev_b32 v84, 2, v93
    s_mov_b32 s39, 0x20000
    v_xor_b32 v84, v84, v0
    s_and_b32 s9, s2, 1
    v_and_b32 v84, 7, v84
    s_lshl3_add_u32 s4, s9, s4
    v_lshlrev_b32 v44, 4, v84
    s_and_b32 s11, s4, 1
    v_mul_u32_u24 v11, 3072, v46
    s_lshr_b32 s35, s4, 1
    s_add_u32 m0, s80, 98304
    s_waitcnt lgkmcnt(0)
    buffer_load_dwordx4 v10, s[36:39], s24 offen  lds
    s_add_u32 m0, s80, 106496
    s_mul_i32 s12, s11, 5
    buffer_load_dwordx4 v45, s[36:39], s24 offen  lds
    s_xor_b32 s35, s35, s12
    s_xor_b32 s35, s35, 1
    s_lshl3_add_u32 s11, s11, s35
    s_lshl_b32 s11, s11, 7
    s_add_u32 s11, s11, 1024
    s_mov_b32 s42, 1572864
    v_add3_u32 v11, v11, v44, s11
    s_mov_b32 s43, 0x20000
    s_add_u32 m0, s80, 32768
    s_mul_i32 s22, s24, 1536
    buffer_load_dwordx4 v11, s[40:43], s22 offen  lds
    s_load_dwordx2 s[64:65], s[0:1], 40
    s_load_dwordx2 s[44:45], s[0:1], 32
    s_load_dwordx2 s[60:61], s[0:1], 16
    s_load_dwordx2 s[56:57], s[0:1], 48
    s_load_dwordx2 s[68:69], s[0:1], 56
    s_load_dwordx2 s[72:73], s[0:1], 64
    s_add_u32 s25, s24, 128
    s_and_b32 s25, s25, 1023
    s_lshr_b32 s5, s5, 6
    s_and_b32 s6, s5, 3
    s_lshr_b32 s7, s5, 2
    s_mov_b32 s54, 268435456
    s_mov_b32 s55, 0x20000
    v_mov_b32 v51, 0
    s_lshl4_add_u32 s86, s3, s4
    s_lshl_b32 s86, s86, 7
    s_add_u32 s86, s86, 4096
    v_min_u32 v5, 1, v0
    v_lshlrev_b32 v5, 30, v5
    s_lshl4_add_u32 s99, s3, s4
    s_lshl3_add_u32 s14, s99, s5
    s_lshl_b32 s14, s14, 10
    v_and_b32 v1, 63, v0
    v_lshlrev_b32 v4, 4, v1
    buffer_load_dword v2, v51, s[52:55], 0 offen sc1
    buffer_load_dword v54, v5, s[52:55], s86 offen sc1
    s_lshl_b32 s99, s99, 7
    s_add_u32 s99, s99, 69632
    s_cmp_eq_u32 s5, 0
    s_cselect_b32 s99, s99, 1073741824
    v_and_b32 v82, 31, v0
    s_waitcnt lgkmcnt(0)
    s_mov_b32 s66, 2752
    s_mov_b32 s67, 0x20000
    s_lshr_b32 s9, s4, 3
    s_sub_u32 s9, s4, s9
    s_cmp_eq_u32 s4, 7
    s_cselect_b32 s9, 15, s9
    s_mul_i32 s9, s9, 192
    s_add_u32 s96, s9, 64
    s_lshl_b32 s13, s4, 6
    s_cmp_ge_u32 s96, 2752
    s_cselect_b32 s96, 1073741824, s96
    s_mov_b32 s82, 1376
    s_mov_b32 s46, 1409024
    s_cmp_eq_u32 s7, 0
    s_cselect_b32 s13, s13, s96
    s_cselect_b32 s96, 1073741824, s96
    s_cselect_b64 s[48:49], s[40:41], s[44:45]
    s_cselect_b32 s50, s42, s46
    s_cselect_b32 s82, 1536, s82
    s_lshl_b32 s97, s7, 7
    s_add_u32 s97, s97, s9
    s_cmp_ge_u32 s97, 2752
    s_cselect_b32 s97, 1073741824, s97
    v_lshl_add_u32 v26, v82, 1, s96
    v_lshl_add_u32 v27, v82, 1, s97
    buffer_load_ushort v26, v26, s[64:67], 0 offen
    buffer_load_ushort v27, v27, s[64:67], 0 offen
    buffer_load_dwordx4 v[252:255], v4, s[36:39], s14 offen
    s_add_u32 m0, s80, 40960
    s_mul_i32 s22, s25, 1536
    buffer_load_dwordx4 v11, s[40:43], s22 offen  lds
    v_bfe_u32 v87, v0, 5, 1
    v_bfe_u32 v81, v0, 6, 2
    v_lshrrev_b32 v80, 8, v0
    v_lshlrev_b32 v84, 1, v80
    v_xor_b32 v84, v84, v81
    v_lshl_add_u32 v92, v81, 5, v82
    v_bfe_u32 v88, v0, 1, 3
    v_xor_b32 v88, v88, v87
    v_lshlrev_b32 v89, 1, v84
    v_xor_b32 v88, v88, v89
    v_lshlrev_b32 v88, 4, v88
    v_lshl_add_u32 v14, v92, 7, v88
    v_add_u32 v14, 98304, v14
    v_bfe_u32 v91, v0, 2, 2
    v_lshl_add_u32 v88, v87, 3, v91
    v_lshl_add_u32 v88, v84, 4, v88
    v_and_b32 v89, 3, v0
    v_lshlrev_b32 v89, 3, v89
    v_lshl_add_u32 v52, v93, 5, v89
    v_bfe_u32 v90, v0, 3, 1
    v_xor_b32 v94, v80, v90
    v_lshl_add_u32 v94, v94, 6, v52
    v_lshl_add_u32 v94, v88, 7, v94
    v_add_u32 v18, 32768, v94
    v_xor_b32 v15, 32, v14
    v_xor_b32 v19, 2048, v18
    v_xor_b32 v16, 64, v14
    v_xor_b32 v20, 4096, v18
    v_xor_b32 v17, 96, v14
    v_xor_b32 v21, 6144, v18
    v_mov_b32 v6, 0x3f803f80
    v_mov_b64 v[30:31], 0
    v_mov_b64 v[32:33], 0
    v_mov_b64 v[56:57], 0
    v_mov_b64 v[58:59], 0
    v_bfe_u32 v94, v0, 1, 1
    v_xor_b32 v94, v94, v87
    v_subrev_u32 v94, 1, v94
    v_and_b32 v94, v94, v6
    v_bfe_i32 v95, v0, 2, 1
    v_and_b32 v62, v95, v94
    v_xor_b32 v60, v62, v94
    v_mov_b32 v63, v62
    v_mov_b32 v61, v60
    v_and_b32 v28, 1, v0
    v_mul_u32_u24 v28, 0xaaaa, v28
    v_add_u32 v28, 0x4444, v28
    s_add_u32 s26, s24, 256
    s_and_b32 s26, s26, 1023
    s_add_u32 s27, s24, 384
    s_and_b32 s27, s27, 1023
    s_add_u32 s28, s24, 512
    s_and_b32 s28, s28, 1023
    s_add_u32 s29, s24, 640
    s_and_b32 s29, s29, 1023
    s_add_u32 s30, s24, 768
    s_and_b32 s30, s30, 1023
    s_add_u32 s31, s24, 896
    s_and_b32 s31, s31, 1023
    s_mov_b32 s47, 0x20000
    s_mov_b32 s51, 0x20000
    v_bfe_u32 v81, v0, 2, 6
    v_mad_u32_u24 v12, v81, s82, v89
    v_mul_u32_u24 v13, 1376, v81
    v_add_u32 v13, v13, v89
    v_lshl_add_u32 v12, v12, 1, s13
    s_bfe_u32 s83, s3, 0x10000
    s_or_b32 s13, s83, s7
    s_cselect_b32 s13, 0, 32
    v_xor_b32 v12, s13, v12
    v_lshl_add_u32 v13, v13, 1, s97
    s_lshl3_add_u32 s90, s7, s6
    s_lshl_b32 s90, s90, 10
    v_lshl_add_u32 v22, v88, 6, v52
    v_lshl_add_u32 v22, v80, 13, v22
    v_add_u32 v22, 131072, v22
    v_xor_b32 v23, 1024, v22
    v_xor_b32 v24, 2048, v22
    v_xor_b32 v25, 3072, v22
    v_lshl_add_u32 v35, s3, 7, v92
    v_lshlrev_b32 v35, 4, v35
    v_add_u32 v29, 90112, v4
    s_lshl4_add_u32 s9, s5, 90112
    v_mov_b32 v36, s9
    v_lshlrev_b32 v37, 4, v82
    v_lshl_add_u32 v37, v80, 10, v37
    v_add_u32 v37, 94208, v37
    v_lshl_add_u32 v38, s6, 2, v37
    s_lshl1_add_u32 s35, s35, s7
    s_lshl4_add_u32 s9, s3, s35
    s_lshl4_add_u32 s9, s9, s6
    s_lshl_b32 s94, s9, 10
    v_and_b32 v43, 15, v0
    v_lshlrev_b32 v43, 4, v43
    v_lshl_or_b32 v43, v87, 8, v43
    v_subrev_u32 v7, 1, v87
    s_mov_b32 s15, 0xffff0000
    s_add_u32 m0, s80, 114688
    s_nop 0
    buffer_load_dwordx4 v10, s[36:39], s25 offen  lds
    s_add_u32 m0, s80, 122880
    s_nop 0
    buffer_load_dwordx4 v45, s[36:39], s25 offen  lds
    s_mov_b64 exec, 0
    s_cmp_eq_u32 s5, 0
    s_cbranch_scc1 L_page1
    s_cmp_eq_u32 s5, 1
    s_cbranch_scc1 L_page2
    s_cmp_eq_u32 s5, 2
    s_cbranch_scc1 L_page3
L_it1:
    s_mov_b64 exec, -1
    s_bitcmp1_b32 s4, 0
    s_cbranch_scc1 L_s1_V
    s_add_u32 s94, s94, 1048576
    s_add_u32 s95, s94, 4096
    v_and_b32 v34, 0x33, v0
    v_bfe_u32 v84, v0, 2, 1
    v_lshl_or_b32 v34, v84, 3, v34
    v_lshl_or_b32 v34, v90, 2, v34
    v_lshlrev_b32 v34, 4, v34
    s_waitcnt vmcnt(8)
    s_barrier
    s_add_u32 m0, s80, 49152
    s_mul_i32 s22, s26, 1536
    buffer_load_dwordx4 v11, s[40:43], s22 offen  lds
    s_add_u32 m0, s80, 131072
    ds_read_b128 v[128:131], v14 offset:0
    buffer_load_dwordx4 v10, s[36:39], s26 offen  lds
    s_add_u32 m0, s80, 139264
    ds_read_b128 v[132:135], v15 offset:0
    buffer_load_dwordx4 v45, s[36:39], s26 offen  lds
    ds_read_b64_tr_b16 v[104:105], v19 offset:0
    ds_read_b64_tr_b16 v[106:107], v19 offset:512
    ds_read_b64_tr_b16 v[108:109], v18 offset:0
    ds_read_b64_tr_b16 v[110:111], v18 offset:512
    ds_read_b128 v[136:139], v16 offset:0
    ds_read_b64_tr_b16 v[100:101], v20 offset:0
    ds_read_b64_tr_b16 v[102:103], v20 offset:512
    ds_read_b128 v[140:143], v17 offset:0
    ds_read_b64_tr_b16 v[96:97], v21 offset:0
    ds_read_b64_tr_b16 v[98:99], v21 offset:512
    s_waitcnt vmcnt(6)
    v_add_u32 v2, 2654435769, v2
    v_dot2c_f32_bf16 v56, v252, v6
    v_dot2c_f32_bf16 v58, v252, v252
    v_dot2c_f32_bf16 v56, v253, v6
    v_dot2c_f32_bf16 v58, v253, v253
    v_dot2c_f32_bf16 v56, v254, v6
    v_dot2c_f32_bf16 v58, v254, v254
    v_dot2c_f32_bf16 v56, v255, v6
    v_dot2c_f32_bf16 v58, v255, v255
    v_mov_b32 v57, v2
    v_mov_b32 v59, v2
    v_add_f32_dpp v56, v56, v56 row_ror:8 row_mask:0xf bank_mask:0xf
    v_add_f32_dpp v58, v58, v58 row_ror:8 row_mask:0xf bank_mask:0xf
    s_nop 0
    v_add_f32_dpp v56, v56, v56 row_ror:4 row_mask:0xf bank_mask:0xf
    v_add_f32_dpp v58, v58, v58 row_ror:4 row_mask:0xf bank_mask:0xf
    s_nop 0
    v_add_f32_dpp v56, v56, v56 row_ror:2 row_mask:0xf bank_mask:0xf
    v_add_f32_dpp v58, v58, v58 row_ror:2 row_mask:0xf bank_mask:0xf
    s_nop 0
    v_add_f32_dpp v56, v56, v56 row_ror:1 row_mask:0xf bank_mask:0xf
    v_add_f32_dpp v58, v58, v58 row_ror:1 row_mask:0xf bank_mask:0xf
    s_nop 0
    v_add_f32_dpp v56, v56, v56 row_bcast:15 row_mask:0xa bank_mask:0xf
    v_add_f32_dpp v58, v58, v58 row_bcast:15 row_mask:0xa bank_mask:0xf
    s_nop 0
    v_add_f32_dpp v56, v56, v56 row_bcast:31 row_mask:0xc bank_mask:0xf
    v_add_f32_dpp v58, v58, v58 row_bcast:31 row_mask:0xc bank_mask:0xf
    v_mul_f32 v56, 0xbb000000, v56
    v_mul_f32 v58, 0x3b000000, v58
    v_fma_f32 v58, -v56, v56, v58
    v_max_f32 v58, 0, v58
    v_add_f32 v58, 0x3727c5ac, v58
    s_bfm_b64 exec, 1, 63
    ds_write_b128 v36, v[56:59]
    s_mov_b64 exec, -1
    s_add_u32 m0, s80, 57344
    s_mul_i32 s22, s27, 1536
    buffer_load_dwordx4 v11, s[40:43], s22 offen  lds
    s_waitcnt vmcnt(4) lgkmcnt(0)
    s_barrier
    ds_read_b128 v[56:59], v29
    v_mfma_f32_32x32x16_bf16 v[64:79], v[108:111], v[128:131], 0
    s_add_u32 m0, s80, 147456
    ds_read_b128 v[144:147], v14 offset:16384
    buffer_load_dwordx4 v10, s[36:39], s27 offen  lds
    v_mfma_f32_32x32x16_bf16 v[64:79], v[104:107], v[132:135], v[64:79]
    s_add_u32 m0, s80, 155648
    ds_read_b128 v[148:151], v15 offset:16384
    buffer_load_dwordx4 v45, s[36:39], s27 offen  lds
    s_waitcnt lgkmcnt(2)
    s_mov_b64 exec, 0xff
    buffer_store_dwordx4 v[56:59], v4, s[52:55], s99 offen sc1
    s_mov_b64 exec, -1
    ds_read_b64_tr_b16 v[116:117], v19 offset:8192
    ds_read_b64_tr_b16 v[118:119], v19 offset:8704
    ds_read_b64_tr_b16 v[112:113], v18 offset:8192
    ds_read_b64_tr_b16 v[114:115], v18 offset:8704
    v_mfma_f32_32x32x16_bf16 v[64:79], v[100:103], v[136:139], v[64:79]
    ds_read_b128 v[152:155], v16 offset:16384
    ds_read_b64_tr_b16 v[120:121], v20 offset:8192
    ds_read_b64_tr_b16 v[122:123], v20 offset:8704
    v_mfma_f32_32x32x16_bf16 v[64:79], v[96:99], v[140:143], v[64:79]
    ds_read_b128 v[156:159], v17 offset:16384
    ds_read_b64_tr_b16 v[124:125], v21 offset:8192
    ds_read_b64_tr_b16 v[126:127], v21 offset:8704
    s_add_u32 m0, s80, 65536
    s_mul_i32 s22, s28, 1536
    buffer_load_dwordx4 v11, s[40:43], s22 offen  lds
    s_waitcnt vmcnt(5) lgkmcnt(0)
    s_barrier
    v_mfma_f32_32x32x16_bf16 v[64:79], v[112:115], v[144:147], v[64:79]
    s_add_u32 m0, s80, 0
    ds_read_b128 v[160:163], v14 offset:32768
    buffer_load_dwordx4 v10, s[36:39], s28 offen  lds
    v_mfma_f32_32x32x16_bf16 v[64:79], v[116:119], v[148:151], v[64:79]
    s_add_u32 m0, s80, 8192
    ds_read_b128 v[164:167], v15 offset:32768
    buffer_load_dwordx4 v45, s[36:39], s28 offen  lds
    v_smfmac_f32_16x16x64_bf16 v[30:33], v[60:63], v[108:115], v28
    ds_read_b64_tr_b16 v[104:105], v19 offset:16384
    ds_read_b64_tr_b16 v[106:107], v19 offset:16896
    ds_read_b64_tr_b16 v[108:109], v18 offset:16384
    ds_read_b64_tr_b16 v[110:111], v18 offset:16896
    v_mfma_f32_32x32x16_bf16 v[64:79], v[120:123], v[152:155], v[64:79]
    ds_read_b128 v[168:171], v16 offset:32768
    ds_read_b64_tr_b16 v[100:101], v20 offset:16384
    ds_read_b64_tr_b16 v[102:103], v20 offset:16896
    v_mfma_f32_32x32x16_bf16 v[64:79], v[124:127], v[156:159], v[64:79]
    ds_read_b128 v[172:175], v17 offset:32768
    ds_read_b64_tr_b16 v[96:97], v21 offset:16384
    ds_read_b64_tr_b16 v[98:99], v21 offset:16896
    s_add_u32 m0, s80, 73728
    s_mul_i32 s22, s29, 1536
    buffer_load_dwordx4 v11, s[40:43], s22 offen  lds
    s_waitcnt vmcnt(5) lgkmcnt(0)
    s_barrier
    v_mfma_f32_32x32x16_bf16 v[64:79], v[108:111], v[160:163], v[64:79]
    s_add_u32 m0, s80, 16384
    ds_read_b128 v[176:179], v14 offset:49152
    buffer_load_dwordx4 v10, s[36:39], s29 offen  lds
    v_mfma_f32_32x32x16_bf16 v[64:79], v[104:107], v[164:167], v[64:79]
    s_add_u32 m0, s80, 24576
    ds_read_b128 v[180:183], v15 offset:49152
    buffer_load_dwordx4 v45, s[36:39], s29 offen  lds
    ds_read_b64_tr_b16 v[116:117], v19 offset:24576
    ds_read_b64_tr_b16 v[118:119], v19 offset:25088
    ds_read_b64_tr_b16 v[112:113], v18 offset:24576
    ds_read_b64_tr_b16 v[114:115], v18 offset:25088
    v_mfma_f32_32x32x16_bf16 v[64:79], v[100:103], v[168:171], v[64:79]
    ds_read_b128 v[184:187], v16 offset:49152
    ds_read_b64_tr_b16 v[120:121], v20 offset:24576
    ds_read_b64_tr_b16 v[122:123], v20 offset:25088
    v_mfma_f32_32x32x16_bf16 v[64:79], v[96:99], v[172:175], v[64:79]
    ds_read_b128 v[188:191], v17 offset:49152
    ds_read_b64_tr_b16 v[124:125], v21 offset:24576
    ds_read_b64_tr_b16 v[126:127], v21 offset:25088
    s_add_u32 m0, s80, 81920
    s_mul_i32 s22, s30, 1536
    buffer_load_dwordx4 v11, s[40:43], s22 offen  lds
    s_waitcnt vmcnt(4) lgkmcnt(0)
    s_barrier
    v_add_u32 v14, 4294868992, v14
    v_add_u32 v15, 4294868992, v15
    v_add_u32 v16, 4294868992, v16
    v_add_u32 v17, 4294868992, v17
    v_mfma_f32_32x32x16_bf16 v[64:79], v[112:115], v[176:179], v[64:79]
    s_add_u32 m0, s80, 98304
    ds_read_b128 v[192:195], v14 offset:0
    buffer_load_dwordx4 v10, s[36:39], s30 offen  lds
    v_mfma_f32_32x32x16_bf16 v[64:79], v[116:119], v[180:183], v[64:79]
    s_add_u32 m0, s80, 106496
    ds_read_b128 v[196:199], v15 offset:0
    buffer_load_dwordx4 v45, s[36:39], s30 offen  lds
    v_smfmac_f32_16x16x64_bf16 v[30:33], v[60:63], v[108:115], v28
    ds_read_b64_tr_b16 v[104:105], v19 offset:32768
    ds_read_b64_tr_b16 v[106:107], v19 offset:33280
    ds_read_b64_tr_b16 v[108:109], v18 offset:32768
    ds_read_b64_tr_b16 v[110:111], v18 offset:33280
    v_mfma_f32_32x32x16_bf16 v[64:79], v[120:123], v[184:187], v[64:79]
    ds_read_b128 v[200:203], v16 offset:0
    ds_read_b64_tr_b16 v[100:101], v20 offset:32768
    ds_read_b64_tr_b16 v[102:103], v20 offset:33280
    v_mfma_f32_32x32x16_bf16 v[64:79], v[124:127], v[188:191], v[64:79]
    ds_read_b128 v[204:207], v17 offset:0
    ds_read_b64_tr_b16 v[96:97], v21 offset:32768
    ds_read_b64_tr_b16 v[98:99], v21 offset:33280
    s_add_u32 m0, s80, 32768
    s_mul_i32 s22, s31, 1536
    buffer_load_dwordx4 v11, s[40:43], s22 offen  lds
    s_waitcnt vmcnt(4) lgkmcnt(0)
    s_barrier
    v_mfma_f32_32x32x16_bf16 v[64:79], v[108:111], v[192:195], v[64:79]
    s_add_u32 m0, s80, 114688
    ds_read_b128 v[208:211], v14 offset:16384
    buffer_load_dwordx4 v10, s[36:39], s31 offen  lds
    v_mfma_f32_32x32x16_bf16 v[64:79], v[104:107], v[196:199], v[64:79]
    s_add_u32 m0, s80, 122880
    ds_read_b128 v[212:215], v15 offset:16384
    buffer_load_dwordx4 v45, s[36:39], s31 offen  lds
    ds_read_b64_tr_b16 v[116:117], v19 offset:40960
    ds_read_b64_tr_b16 v[118:119], v19 offset:41472
    ds_read_b64_tr_b16 v[112:113], v18 offset:40960
    ds_read_b64_tr_b16 v[114:115], v18 offset:41472
    v_mfma_f32_32x32x16_bf16 v[64:79], v[100:103], v[200:203], v[64:79]
    ds_read_b128 v[216:219], v16 offset:16384
    ds_read_b64_tr_b16 v[120:121], v20 offset:40960
    ds_read_b64_tr_b16 v[122:123], v20 offset:41472
    v_mfma_f32_32x32x16_bf16 v[64:79], v[96:99], v[204:207], v[64:79]
    ds_read_b128 v[220:223], v17 offset:16384
    ds_read_b64_tr_b16 v[124:125], v21 offset:40960
    ds_read_b64_tr_b16 v[126:127], v21 offset:41472
    s_mov_b32 s23, 69632
    buffer_load_dwordx4 v[56:59], v35, s[52:55], s23 offen sc1
    s_add_u32 m0, s90, 131072
    s_mul_i32 s22, s24, s82
    buffer_load_dwordx4 v12, s[48:51], s22 offen lds
    s_waitcnt vmcnt(5) lgkmcnt(0)
    s_barrier
    v_add_u32 v14, 98304, v14
    v_add_u32 v15, 98304, v15
    v_add_u32 v16, 98304, v16
    v_add_u32 v17, 98304, v17
    v_mfma_f32_32x32x16_bf16 v[64:79], v[112:115], v[208:211], v[64:79]
    s_add_u32 m0, s90, 135168
    s_mul_i32 s22, s24, 1376
    buffer_load_dwordx4 v13, s[44:47], s22 offen lds
    v_mfma_f32_32x32x16_bf16 v[64:79], v[116:119], v[212:215], v[64:79]
    ds_read_b128 v[224:227], v14 offset:0
    ds_read_b128 v[228:231], v15 offset:0
    s_waitcnt vmcnt(2)
    v_cmp_ne_u32 vcc, v57, v2
    v_cmp_ne_u32 s[12:13], v59, v2
    s_or_b64 vcc, vcc, s[12:13]
    s_cbranch_scc1 L_spin_1
L_back_2:
    v_smfmac_f32_16x16x64_bf16 v[30:33], v[60:63], v[108:115], v28
    ds_read_b64_tr_b16 v[104:105], v19 offset:49152
    ds_read_b64_tr_b16 v[106:107], v19 offset:49664
    ds_read_b64_tr_b16 v[108:109], v18 offset:49152
    ds_read_b64_tr_b16 v[110:111], v18 offset:49664
    v_rsq_f32 v8, v58
    v_cvt_pk_bf16_f32 v57, v56, v56
    v_cvt_pk_bf16_f32 v49, v56, 0
    v_mul_f32 v58, v58, v8
    v_and_b32 v57, s15, v57
    v_cvt_pk_bf16_f32 v59, v58, v58
    v_mfma_f32_32x32x16_bf16 v[64:79], v[120:123], v[216:219], v[64:79]
    ds_read_b128 v[232:235], v16 offset:0
    ds_read_b64_tr_b16 v[100:101], v20 offset:49152
    ds_read_b64_tr_b16 v[102:103], v20 offset:49664
    v_sub_f32 v57, v56, v57
    v_and_b32 v59, s15, v59
    v_cvt_pk_bf16_f32 v48, v56, v57
    v_sub_f32 v59, v58, v59
    v_and_b32 v49, v7, v49
    v_cvt_pk_bf16_f32 v50, v58, v59
    v_mfma_f32_32x32x16_bf16 v[64:79], v[124:127], v[220:223], v[64:79]
    ds_read_b128 v[236:239], v17 offset:0
    ds_read_b64_tr_b16 v[96:97], v21 offset:49152
    ds_read_b64_tr_b16 v[98:99], v21 offset:49664
    v_and_b32 v48, v7, v48
    v_and_b32 v50, v7, v50
    s_add_u32 m0, s90, 147456
    s_mul_i32 s22, s25, s82
    buffer_load_dwordx4 v12, s[48:51], s22 offen lds
    s_waitcnt lgkmcnt(0)
    s_barrier
    ds_read_b64_tr_b16 v[112:113], v18 offset:0
    ds_read_b64_tr_b16 v[114:115], v18 offset:512
    ds_read_b128 v[240:243], v14 offset:16384
    ds_read_b128 v[244:247], v15 offset:16384
    v_mfma_f32_32x32x16_bf16 v[64:79], v[108:111], v[224:227], v[64:79]
    ds_read_b64_tr_b16 v[116:117], v19 offset:0
    ds_read_b64_tr_b16 v[118:119], v19 offset:512
    s_add_u32 m0, s90, 151552
    s_mul_i32 s22, s25, 1376
    buffer_load_dwordx4 v13, s[44:47], s22 offen lds
    s_waitcnt lgkmcnt(4)
    v_smfmac_f32_16x16x64_bf16 v[30:33], v[60:63], v[108:115], v28
    ds_read_b128 v[248:251], v16 offset:16384
    ds_read_b64_tr_b16 v[120:121], v20 offset:0
    ds_read_b64_tr_b16 v[122:123], v20 offset:512
    v_mfma_f32_32x32x16_bf16 v[64:79], v[104:107], v[228:231], v[64:79]
    ds_read_b128 v[252:255], v17 offset:16384
    ds_read_b64_tr_b16 v[124:125], v21 offset:0
    ds_read_b64_tr_b16 v[126:127], v21 offset:512
    s_nop 0
    v_add_f32 v30, v30, v31
    v_add_f32 v32, v32, v33
    v_add_f32 v30, v30, v32
    ds_write_b32 v38, v30
    v_mfma_f32_32x32x16_bf16 v[64:79], v[100:103], v[232:235], v[64:79]
    s_waitcnt lgkmcnt(0)
    s_barrier
    ds_read_b128 v[80:83], v37
    v_mfma_f32_32x32x16_bf16 v[64:79], v[96:99], v[236:239], v[64:79]
    s_add_u32 m0, s90, 40960
    s_mul_i32 s22, s26, s82
    buffer_load_dwordx4 v12, s[48:51], s22 offen lds
    s_add_u32 m0, s90, 45056
    s_mul_i32 s22, s26, 1376
    buffer_load_dwordx4 v13, s[44:47], s22 offen lds
    v_mfma_f32_32x32x16_bf16 v[64:79], v[112:115], v[240:243], v[64:79]
    v_mov_b32 v30, 0
    v_mov_b32 v31, 0
    v_mov_b32 v32, 0
    v_mov_b32 v33, 0
    v_mov_b32 v94, 0
    v_mov_b32 v95, 0
    v_mfma_f32_32x32x16_bf16 v[64:79], v[116:119], v[244:247], v[64:79]
    s_waitcnt lgkmcnt(0)
    v_add_f32 v80, v80, v81
    v_add_f32 v82, v82, v83
    v_add_f32 v80, v80, v82
    v_cvt_pk_bf16_f32 v92, v80, v80
    v_mfma_f32_32x32x16_bf16 v[64:79], v[120:123], v[248:251], v[64:79]
    v_and_b32 v81, s15, v92
    v_sub_f32 v81, v80, v81
    v_cvt_pk_bf16_f32 v93, v81, 0
    v_mfma_f32_32x32x16_bf16 v[64:79], v[124:127], v[252:255], v[64:79]
    s_nop 0
    v_mfma_f32_32x32x16_bf16 v[64:79], v[92:95], v[48:51], v[64:79]
    s_waitcnt vmcnt(4)
    s_barrier
    ds_read_b64_tr_b16 v[112:113], v22 offset:0
    ds_read_b64_tr_b16 v[114:115], v22 offset:256
    ds_read_b64_tr_b16 v[116:117], v22 offset:4096
    ds_read_b64_tr_b16 v[118:119], v22 offset:4352
    ds_read_b64_tr_b16 v[120:121], v23 offset:0
    ds_read_b64_tr_b16 v[122:123], v23 offset:256
    ds_read_b64_tr_b16 v[124:125], v23 offset:4096
    ds_read_b64_tr_b16 v[126:127], v23 offset:4352
    s_nop 1
    v_pk_mul_f32 v[64:65], v[64:65], v[8:9] op_sel_hi:[1,0]
    v_pk_mul_f32 v[66:67], v[66:67], v[8:9] op_sel_hi:[1,0]
    v_pk_mul_f32 v[68:69], v[68:69], v[8:9] op_sel_hi:[1,0]
    v_pk_mul_f32 v[70:71], v[70:71], v[8:9] op_sel_hi:[1,0]
    v_cvt_pk_bf16_f32 v14, v64, v65
    v_cvt_pk_bf16_f32 v15, v66, v67
    v_cvt_pk_bf16_f32 v16, v68, v69
    v_cvt_pk_bf16_f32 v17, v70, v71
    buffer_store_dwordx4 v[14:17], v34, s[52:55], s94 offen sc1
    v_pk_mul_f32 v[72:73], v[72:73], v[8:9] op_sel_hi:[1,0]
    v_pk_mul_f32 v[74:75], v[74:75], v[8:9] op_sel_hi:[1,0]
    v_pk_mul_f32 v[76:77], v[76:77], v[8:9] op_sel_hi:[1,0]
    v_pk_mul_f32 v[78:79], v[78:79], v[8:9] op_sel_hi:[1,0]
    v_cvt_pk_bf16_f32 v18, v72, v73
    v_cvt_pk_bf16_f32 v19, v74, v75
    v_cvt_pk_bf16_f32 v20, v76, v77
    v_cvt_pk_bf16_f32 v21, v78, v79
    s_branch L_s1_done
.p2align 12
.fill 176, 4, 0xbf800000
L_s1_V:
L_page1:
    s_cbranch_execz L_it1
    s_add_u32 s94, s94, 1056768
    s_add_u32 s95, s94, 512
    v_lshl_or_b32 v34, v93, 12, v43
    s_waitcnt vmcnt(8)
    s_barrier
    s_add_u32 m0, s80, 49152
    s_mul_i32 s22, s26, 1536
    buffer_load_dwordx4 v11, s[40:43], s22 offen  lds
    s_add_u32 m0, s80, 131072
    ds_read_b128 v[128:131], v14 offset:0
    buffer_load_dwordx4 v10, s[36:39], s26 offen  lds
    s_add_u32 m0, s80, 139264
    ds_read_b128 v[132:135], v15 offset:0
    buffer_load_dwordx4 v45, s[36:39], s26 offen  lds
    ds_read_b64_tr_b16 v[104:105], v19 offset:0
    ds_read_b64_tr_b16 v[106:107], v19 offset:512
    ds_read_b64_tr_b16 v[108:109], v18 offset:0
    ds_read_b64_tr_b16 v[110:111], v18 offset:512
    ds_read_b128 v[136:139], v16 offset:0
    ds_read_b64_tr_b16 v[100:101], v20 offset:0
    ds_read_b64_tr_b16 v[102:103], v20 offset:512
    ds_read_b128 v[140:143], v17 offset:0
    ds_read_b64_tr_b16 v[96:97], v21 offset:0
    ds_read_b64_tr_b16 v[98:99], v21 offset:512
    s_waitcnt vmcnt(6)
    v_add_u32 v2, 2654435769, v2
    v_dot2c_f32_bf16 v56, v252, v6
    v_dot2c_f32_bf16 v58, v252, v252
    v_dot2c_f32_bf16 v56, v253, v6
    v_dot2c_f32_bf16 v58, v253, v253
    v_dot2c_f32_bf16 v56, v254, v6
    v_dot2c_f32_bf16 v58, v254, v254
    v_dot2c_f32_bf16 v56, v255, v6
    v_dot2c_f32_bf16 v58, v255, v255
    v_mov_b32 v57, v2
    v_mov_b32 v59, v2
    v_add_f32_dpp v56, v56, v56 row_ror:8 row_mask:0xf bank_mask:0xf
    v_add_f32_dpp v58, v58, v58 row_ror:8 row_mask:0xf bank_mask:0xf
    s_nop 0
    v_add_f32_dpp v56, v56, v56 row_ror:4 row_mask:0xf bank_mask:0xf
    v_add_f32_dpp v58, v58, v58 row_ror:4 row_mask:0xf bank_mask:0xf
    s_nop 0
    v_add_f32_dpp v56, v56, v56 row_ror:2 row_mask:0xf bank_mask:0xf
    v_add_f32_dpp v58, v58, v58 row_ror:2 row_mask:0xf bank_mask:0xf
    s_nop 0
    v_add_f32_dpp v56, v56, v56 row_ror:1 row_mask:0xf bank_mask:0xf
    v_add_f32_dpp v58, v58, v58 row_ror:1 row_mask:0xf bank_mask:0xf
    s_nop 0
    v_add_f32_dpp v56, v56, v56 row_bcast:15 row_mask:0xa bank_mask:0xf
    v_add_f32_dpp v58, v58, v58 row_bcast:15 row_mask:0xa bank_mask:0xf
    s_nop 0
    v_add_f32_dpp v56, v56, v56 row_bcast:31 row_mask:0xc bank_mask:0xf
    v_add_f32_dpp v58, v58, v58 row_bcast:31 row_mask:0xc bank_mask:0xf
    v_mul_f32 v56, 0xbb000000, v56
    v_mul_f32 v58, 0x3b000000, v58
    v_fma_f32 v58, -v56, v56, v58
    v_max_f32 v58, 0, v58
    v_add_f32 v58, 0x3727c5ac, v58
    s_bfm_b64 exec, 1, 63
    ds_write_b128 v36, v[56:59]
    s_mov_b64 exec, -1
    s_add_u32 m0, s80, 57344
    s_mul_i32 s22, s27, 1536
    buffer_load_dwordx4 v11, s[40:43], s22 offen  lds
    s_waitcnt vmcnt(4) lgkmcnt(0)
    s_barrier
    ds_read_b128 v[56:59], v29
    v_mfma_f32_32x32x16_bf16 v[64:79], v[128:131], v[108:111], 0
    s_add_u32 m0, s80, 147456
    ds_read_b128 v[144:147], v14 offset:16384
    buffer_load_dwordx4 v10, s[36:39], s27 offen  lds
    v_mfma_f32_32x32x16_bf16 v[64:79], v[132:135], v[104:107], v[64:79]
    s_add_u32 m0, s80, 155648
    ds_read_b128 v[148:151], v15 offset:16384
    buffer_load_dwordx4 v45, s[36:39], s27 offen  lds
    s_waitcnt lgkmcnt(2)
    s_mov_b64 exec, 0xff
    buffer_store_dwordx4 v[56:59], v4, s[52:55], s99 offen sc1
    s_mov_b64 exec, -1
    ds_read_b64_tr_b16 v[116:117], v19 offset:8192
    ds_read_b64_tr_b16 v[118:119], v19 offset:8704
    ds_read_b64_tr_b16 v[112:113], v18 offset:8192
    ds_read_b64_tr_b16 v[114:115], v18 offset:8704
    v_mfma_f32_32x32x16_bf16 v[64:79], v[136:139], v[100:103], v[64:79]
    ds_read_b128 v[152:155], v16 offset:16384
    ds_read_b64_tr_b16 v[120:121], v20 offset:8192
    ds_read_b64_tr_b16 v[122:123], v20 offset:8704
    v_mfma_f32_32x32x16_bf16 v[64:79], v[140:143], v[96:99], v[64:79]
    ds_read_b128 v[156:159], v17 offset:16384
    ds_read_b64_tr_b16 v[124:125], v21 offset:8192
    ds_read_b64_tr_b16 v[126:127], v21 offset:8704
    s_add_u32 m0, s80, 65536
    s_mul_i32 s22, s28, 1536
    buffer_load_dwordx4 v11, s[40:43], s22 offen  lds
    s_waitcnt vmcnt(5) lgkmcnt(0)
    s_barrier
    v_mfma_f32_32x32x16_bf16 v[64:79], v[144:147], v[112:115], v[64:79]
    s_add_u32 m0, s80, 0
    ds_read_b128 v[160:163], v14 offset:32768
    buffer_load_dwordx4 v10, s[36:39], s28 offen  lds
    v_mfma_f32_32x32x16_bf16 v[64:79], v[148:151], v[116:119], v[64:79]
    s_add_u32 m0, s80, 8192
    ds_read_b128 v[164:167], v15 offset:32768
    buffer_load_dwordx4 v45, s[36:39], s28 offen  lds
    v_smfmac_f32_16x16x64_bf16 v[30:33], v[60:63], v[108:115], v28
    ds_read_b64_tr_b16 v[104:105], v19 offset:16384
    ds_read_b64_tr_b16 v[106:107], v19 offset:16896
    ds_read_b64_tr_b16 v[108:109], v18 offset:16384
    ds_read_b64_tr_b16 v[110:111], v18 offset:16896
    v_mfma_f32_32x32x16_bf16 v[64:79], v[152:155], v[120:123], v[64:79]
    ds_read_b128 v[168:171], v16 offset:32768
    ds_read_b64_tr_b16 v[100:101], v20 offset:16384
    ds_read_b64_tr_b16 v[102:103], v20 offset:16896
    v_mfma_f32_32x32x16_bf16 v[64:79], v[156:159], v[124:127], v[64:79]
    ds_read_b128 v[172:175], v17 offset:32768
    ds_read_b64_tr_b16 v[96:97], v21 offset:16384
    ds_read_b64_tr_b16 v[98:99], v21 offset:16896
    s_add_u32 m0, s80, 73728
    s_mul_i32 s22, s29, 1536
    buffer_load_dwordx4 v11, s[40:43], s22 offen  lds
    s_waitcnt vmcnt(5) lgkmcnt(0)
    s_barrier
    v_mfma_f32_32x32x16_bf16 v[64:79], v[160:163], v[108:111], v[64:79]
    s_add_u32 m0, s80, 16384
    ds_read_b128 v[176:179], v14 offset:49152
    buffer_load_dwordx4 v10, s[36:39], s29 offen  lds
    v_mfma_f32_32x32x16_bf16 v[64:79], v[164:167], v[104:107], v[64:79]
    s_add_u32 m0, s80, 24576
    ds_read_b128 v[180:183], v15 offset:49152
    buffer_load_dwordx4 v45, s[36:39], s29 offen  lds
    ds_read_b64_tr_b16 v[116:117], v19 offset:24576
    ds_read_b64_tr_b16 v[118:119], v19 offset:25088
    ds_read_b64_tr_b16 v[112:113], v18 offset:24576
    ds_read_b64_tr_b16 v[114:115], v18 offset:25088
    v_mfma_f32_32x32x16_bf16 v[64:79], v[168:171], v[100:103], v[64:79]
    ds_read_b128 v[184:187], v16 offset:49152
    ds_read_b64_tr_b16 v[120:121], v20 offset:24576
    ds_read_b64_tr_b16 v[122:123], v20 offset:25088
    v_mfma_f32_32x32x16_bf16 v[64:79], v[172:175], v[96:99], v[64:79]
    ds_read_b128 v[188:191], v17 offset:49152
    ds_read_b64_tr_b16 v[124:125], v21 offset:24576
    ds_read_b64_tr_b16 v[126:127], v21 offset:25088
    s_add_u32 m0, s80, 81920
    s_mul_i32 s22, s30, 1536
    buffer_load_dwordx4 v11, s[40:43], s22 offen  lds
    s_waitcnt vmcnt(4) lgkmcnt(0)
    s_barrier
    v_add_u32 v14, 4294868992, v14
    v_add_u32 v15, 4294868992, v15
    v_add_u32 v16, 4294868992, v16
    v_add_u32 v17, 4294868992, v17
    v_mfma_f32_32x32x16_bf16 v[64:79], v[176:179], v[112:115], v[64:79]
    s_add_u32 m0, s80, 98304
    ds_read_b128 v[192:195], v14 offset:0
    buffer_load_dwordx4 v10, s[36:39], s30 offen  lds
    v_mfma_f32_32x32x16_bf16 v[64:79], v[180:183], v[116:119], v[64:79]
    s_add_u32 m0, s80, 106496
    ds_read_b128 v[196:199], v15 offset:0
    buffer_load_dwordx4 v45, s[36:39], s30 offen  lds
    v_smfmac_f32_16x16x64_bf16 v[30:33], v[60:63], v[108:115], v28
    ds_read_b64_tr_b16 v[104:105], v19 offset:32768
    ds_read_b64_tr_b16 v[106:107], v19 offset:33280
    ds_read_b64_tr_b16 v[108:109], v18 offset:32768
    ds_read_b64_tr_b16 v[110:111], v18 offset:33280
    v_mfma_f32_32x32x16_bf16 v[64:79], v[184:187], v[120:123], v[64:79]
    ds_read_b128 v[200:203], v16 offset:0
    ds_read_b64_tr_b16 v[100:101], v20 offset:32768
    ds_read_b64_tr_b16 v[102:103], v20 offset:33280
    v_mfma_f32_32x32x16_bf16 v[64:79], v[188:191], v[124:127], v[64:79]
    ds_read_b128 v[204:207], v17 offset:0
    ds_read_b64_tr_b16 v[96:97], v21 offset:32768
    ds_read_b64_tr_b16 v[98:99], v21 offset:33280
    s_add_u32 m0, s80, 32768
    s_mul_i32 s22, s31, 1536
    buffer_load_dwordx4 v11, s[40:43], s22 offen  lds
    s_waitcnt vmcnt(4) lgkmcnt(0)
    s_barrier
    v_mfma_f32_32x32x16_bf16 v[64:79], v[192:195], v[108:111], v[64:79]
    s_add_u32 m0, s80, 114688
    ds_read_b128 v[208:211], v14 offset:16384
    buffer_load_dwordx4 v10, s[36:39], s31 offen  lds
    v_mfma_f32_32x32x16_bf16 v[64:79], v[196:199], v[104:107], v[64:79]
    s_add_u32 m0, s80, 122880
    ds_read_b128 v[212:215], v15 offset:16384
    buffer_load_dwordx4 v45, s[36:39], s31 offen  lds
    ds_read_b64_tr_b16 v[116:117], v19 offset:40960
    ds_read_b64_tr_b16 v[118:119], v19 offset:41472
    ds_read_b64_tr_b16 v[112:113], v18 offset:40960
    ds_read_b64_tr_b16 v[114:115], v18 offset:41472
    v_mfma_f32_32x32x16_bf16 v[64:79], v[200:203], v[100:103], v[64:79]
    ds_read_b128 v[216:219], v16 offset:16384
    ds_read_b64_tr_b16 v[120:121], v20 offset:40960
    ds_read_b64_tr_b16 v[122:123], v20 offset:41472
    v_mfma_f32_32x32x16_bf16 v[64:79], v[204:207], v[96:99], v[64:79]
    ds_read_b128 v[220:223], v17 offset:16384
    ds_read_b64_tr_b16 v[124:125], v21 offset:40960
    ds_read_b64_tr_b16 v[126:127], v21 offset:41472
    s_mov_b32 s23, 69632
    buffer_load_dwordx4 v[56:59], v35, s[52:55], s23 offen sc1
    s_add_u32 m0, s90, 131072
    s_mul_i32 s22, s24, s82
    buffer_load_dwordx4 v12, s[48:51], s22 offen lds
    s_waitcnt vmcnt(5) lgkmcnt(0)
    s_barrier
    v_add_u32 v14, 98304, v14
    v_add_u32 v15, 98304, v15
    v_add_u32 v16, 98304, v16
    v_add_u32 v17, 98304, v17
    v_mfma_f32_32x32x16_bf16 v[64:79], v[208:211], v[112:115], v[64:79]
    s_add_u32 m0, s90, 135168
    s_mul_i32 s22, s24, 1376
    buffer_load_dwordx4 v13, s[44:47], s22 offen lds
    v_mfma_f32_32x32x16_bf16 v[64:79], v[212:215], v[116:119], v[64:79]
    ds_read_b128 v[224:227], v14 offset:0
    ds_read_b128 v[228:231], v15 offset:0
    s_waitcnt vmcnt(2)
    v_cmp_ne_u32 vcc, v57, v2
    v_cmp_ne_u32 s[12:13], v59, v2
    s_or_b64 vcc, vcc, s[12:13]
    s_cbranch_scc1 L_spin_4
L_back_5:
    v_smfmac_f32_16x16x64_bf16 v[30:33], v[60:63], v[108:115], v28
    ds_read_b64_tr_b16 v[104:105], v19 offset:49152
    ds_read_b64_tr_b16 v[106:107], v19 offset:49664
    ds_read_b64_tr_b16 v[108:109], v18 offset:49152
    ds_read_b64_tr_b16 v[110:111], v18 offset:49664
    v_rsq_f32 v8, v58
    v_cvt_pk_bf16_f32 v57, v56, v56
    v_cvt_pk_bf16_f32 v49, v56, 0
    v_mul_f32 v58, v58, v8
    v_and_b32 v57, s15, v57
    v_cvt_pk_bf16_f32 v59, v58, v58
    v_mfma_f32_32x32x16_bf16 v[64:79], v[216:219], v[120:123], v[64:79]
    ds_read_b128 v[232:235], v16 offset:0
    ds_read_b64_tr_b16 v[100:101], v20 offset:49152
    ds_read_b64_tr_b16 v[102:103], v20 offset:49664
    v_sub_f32 v57, v56, v57
    v_and_b32 v59, s15, v59
    v_cvt_pk_bf16_f32 v48, v56, v57
    v_sub_f32 v59, v58, v59
    v_and_b32 v49, v7, v49
    v_cvt_pk_bf16_f32 v50, v58, v59
    v_mfma_f32_32x32x16_bf16 v[64:79], v[220:223], v[124:127], v[64:79]
    ds_read_b128 v[236:239], v17 offset:0
    ds_read_b64_tr_b16 v[96:97], v21 offset:49152
    ds_read_b64_tr_b16 v[98:99], v21 offset:49664
    v_and_b32 v48, v7, v48
    v_and_b32 v50, v7, v50
    v_cvt_pk_bf16_f32 v57, v8, v8
    v_and_b32 v57, s15, v57
    v_sub_f32 v57, v8, v57
    v_cvt_pk_bf16_f32 v56, v8, v57
    v_mov_b32 v57, 0
    v_and_b32 v56, v7, v56
    v_mov_b32 v58, 0
    v_mov_b32 v59, 0
    s_add_u32 m0, s90, 147456
    s_mul_i32 s22, s25, s82
    buffer_load_dwordx4 v12, s[48:51], s22 offen lds
    s_waitcnt lgkmcnt(0)
    s_barrier
    ds_read_b64_tr_b16 v[112:113], v18 offset:0
    ds_read_b64_tr_b16 v[114:115], v18 offset:512
    ds_read_b128 v[240:243], v14 offset:16384
    ds_read_b128 v[244:247], v15 offset:16384
    v_mfma_f32_32x32x16_bf16 v[64:79], v[224:227], v[108:111], v[64:79]
    ds_read_b64_tr_b16 v[116:117], v19 offset:0
    ds_read_b64_tr_b16 v[118:119], v19 offset:512
    s_add_u32 m0, s90, 151552
    s_mul_i32 s22, s25, 1376
    buffer_load_dwordx4 v13, s[44:47], s22 offen lds
    s_waitcnt lgkmcnt(4)
    v_smfmac_f32_16x16x64_bf16 v[30:33], v[60:63], v[108:115], v28
    ds_read_b128 v[248:251], v16 offset:16384
    ds_read_b64_tr_b16 v[120:121], v20 offset:0
    ds_read_b64_tr_b16 v[122:123], v20 offset:512
    v_mfma_f32_32x32x16_bf16 v[64:79], v[228:231], v[104:107], v[64:79]
    ds_read_b128 v[252:255], v17 offset:16384
    ds_read_b64_tr_b16 v[124:125], v21 offset:0
    ds_read_b64_tr_b16 v[126:127], v21 offset:512
    s_nop 0
    v_add_f32 v30, v30, v31
    v_add_f32 v32, v32, v33
    v_add_f32 v30, v30, v32
    ds_write_b32 v38, v30
    v_mfma_f32_32x32x16_bf16 v[64:79], v[232:235], v[100:103], v[64:79]
    s_waitcnt lgkmcnt(0)
    s_barrier
    ds_read_b128 v[80:83], v37
    v_mfma_f32_32x32x16_bf16 v[64:79], v[236:239], v[96:99], v[64:79]
    s_add_u32 m0, s90, 40960
    s_mul_i32 s22, s26, s82
    buffer_load_dwordx4 v12, s[48:51], s22 offen lds
    s_add_u32 m0, s90, 45056
    s_mul_i32 s22, s26, 1376
    buffer_load_dwordx4 v13, s[44:47], s22 offen lds
    v_mfma_f32_32x32x16_bf16 v[64:79], v[240:243], v[112:115], v[64:79]
    v_mov_b32 v30, 0
    v_mov_b32 v31, 0
    v_mov_b32 v32, 0
    v_mov_b32 v33, 0
    v_mov_b32 v94, 0
    v_mov_b32 v95, 0
    v_mfma_f32_32x32x16_bf16 v[64:79], v[244:247], v[116:119], v[64:79]
    s_waitcnt lgkmcnt(0)
    v_add_f32 v80, v80, v81
    v_add_f32 v82, v82, v83
    v_add_f32 v80, v80, v82
    v_cvt_pk_bf16_f32 v92, v80, v80
    v_mfma_f32_32x32x16_bf16 v[64:79], v[248:251], v[120:123], v[64:79]
    v_and_b32 v81, s15, v92
    v_sub_f32 v81, v80, v81
    v_cvt_pk_bf16_f32 v93, v81, 0
    v_mov_b32 v96, v6
    v_mov_b32 v97, v6
    v_mov_b32 v98, v6
    v_mov_b32 v99, v6
    v_mfma_f32_32x32x16_bf16 v[64:79], v[252:255], v[124:127], v[64:79]
    v_mfma_f32_32x32x16_bf16 v[64:79], v[48:51], v[92:95], v[64:79]
    v_mfma_f32_32x32x16_bf16 v[80:95], v[56:59], v[96:99], 0
    s_waitcnt vmcnt(4)
    s_barrier
    ds_read_b64_tr_b16 v[112:113], v22 offset:0
    ds_read_b64_tr_b16 v[114:115], v22 offset:256
    ds_read_b64_tr_b16 v[116:117], v22 offset:4096
    ds_read_b64_tr_b16 v[118:119], v22 offset:4352
    ds_read_b64_tr_b16 v[120:121], v23 offset:0
    ds_read_b64_tr_b16 v[122:123], v23 offset:256
    ds_read_b64_tr_b16 v[124:125], v23 offset:4096
    ds_read_b64_tr_b16 v[126:127], v23 offset:4352
    s_nop 1
    v_pk_mul_f32 v[64:65], v[64:65], v[80:81]
    v_pk_mul_f32 v[66:67], v[66:67], v[82:83]
    v_pk_mul_f32 v[68:69], v[68:69], v[84:85]
    v_pk_mul_f32 v[70:71], v[70:71], v[86:87]
    v_cvt_pk_bf16_f32 v14, v64, v65
    v_cvt_pk_bf16_f32 v15, v66, v67
    v_cvt_pk_bf16_f32 v16, v68, v69
    v_cvt_pk_bf16_f32 v17, v70, v71
    buffer_store_dwordx4 v[14:17], v34, s[52:55], s94 offen sc1
    v_pk_mul_f32 v[72:73], v[72:73], v[88:89]
    v_pk_mul_f32 v[74:75], v[74:75], v[90:91]
    v_pk_mul_f32 v[76:77], v[76:77], v[92:93]
    v_pk_mul_f32 v[78:79], v[78:79], v[94:95]
    v_cvt_pk_bf16_f32 v18, v72, v73
    v_cvt_pk_bf16_f32 v19, v74, v75
    v_cvt_pk_bf16_f32 v20, v76, v77
    v_cvt_pk_bf16_f32 v21, v78, v79
L_s1_done:
    s_nop 1
    s_waitcnt lgkmcnt(6)
    v_mfma_f32_32x32x16_bf16 v[64:79], v[112:115], v[128:131], 0
    ds_read_b64_tr_b16 v[96:97], v24 offset:0
    ds_read_b64_tr_b16 v[98:99], v24 offset:256
    v_lshlrev_b32 v41, 4, v0
    v_add_u32 v41, 32768, v41
    s_and_b32 s9, s5, 1
    s_lshl1_add_u32 s9, s9, 24
    s_waitcnt lgkmcnt(6)
    v_mfma_f32_32x32x16_bf16 v[80:95], v[116:119], v[128:131], 0
    ds_read_b64_tr_b16 v[100:101], v24 offset:4096
    ds_read_b64_tr_b16 v[102:103], v24 offset:4352
    v_smfmac_f32_16x16x64_bf16 v[30:33], v[60:63], v[112:119], v28
    v_lshl_add_u32 v42, s9, 12, v4
    s_add_u32 s9, s9, 1
    v_lshl_add_u32 v43, s9, 12, v43
    s_lshl_b32 s9, s7, 0
    s_waitcnt lgkmcnt(6)
    v_mfma_f32_32x32x16_bf16 v[64:79], v[120:123], v[132:135], v[64:79]
    ds_read_b64_tr_b16 v[104:105], v25 offset:0
    ds_read_b64_tr_b16 v[106:107], v25 offset:256
    s_add_u32 m0, s90, 0
    s_mul_i32 s22, s27, s82
    buffer_load_dwordx4 v12, s[48:51], s22 offen lds
    s_xor_b32 s9, s9, s3
    s_lshl4_add_u32 s19, s9, s4
    s_lshl2_add_u32 s19, s19, s6
    s_lshl_b32 s19, s19, 11
    s_waitcnt lgkmcnt(6)
    v_mfma_f32_32x32x16_bf16 v[80:95], v[124:127], v[132:135], v[80:95]
    ds_read_b64_tr_b16 v[108:109], v25 offset:4096
    ds_read_b64_tr_b16 v[110:111], v25 offset:4352
    s_add_u32 s19, s19, 13631488
    s_lshl2_add_u32 s9, s9, s6
    s_lshl4_add_u32 s98, s9, s4
    s_lshl1_add_u32 s98, s98, s83
    s_waitcnt lgkmcnt(6)
    v_mfma_f32_32x32x16_bf16 v[64:79], v[96:99], v[136:139], v[64:79]
    s_waitcnt vmcnt(4)
    s_barrier
    ds_read_b64_tr_b16 v[112:113], v22 offset:16384
    ds_read_b64_tr_b16 v[114:115], v22 offset:16640
    s_lshl2_add_u32 s10, s3, s6
    s_lshl_b32 s34, s98, 7
    s_add_u32 s34, s34, 786432
    s_lshl_b32 s98, s98, 10
    s_waitcnt lgkmcnt(6)
    v_mfma_f32_32x32x16_bf16 v[80:95], v[100:103], v[136:139], v[80:95]
    ds_read_b64_tr_b16 v[116:117], v22 offset:20480
    ds_read_b64_tr_b16 v[118:119], v22 offset:20736
    s_add_u32 m0, s90, 4096
    s_mul_i32 s22, s27, 1376
    buffer_load_dwordx4 v13, s[44:47], s22 offen lds
    s_add_u32 s98, s98, 5242880
    s_mul_i32 s10, s10, 88064
    s_add_u32 s10, s10, 7340032
    s_lshl_b32 s11, s96, 5
    s_waitcnt lgkmcnt(6)
    v_mfma_f32_32x32x16_bf16 v[64:79], v[104:107], v[140:143], v[64:79]
    ds_read_b64_tr_b16 v[120:121], v23 offset:16384
    ds_read_b64_tr_b16 v[122:123], v23 offset:16640
    buffer_store_dwordx4 v[18:21], v34, s[52:55], s95 offen sc1
    s_add_u32 s11, s11, s10
    s_max_u32 s96, s96, s11
    s_lshl_b32 s11, s97, 5
    s_add_u32 s11, s11, s10
    s_waitcnt lgkmcnt(6)
    v_mfma_f32_32x32x16_bf16 v[80:95], v[108:111], v[140:143], v[80:95]
    ds_read_b64_tr_b16 v[124:125], v23 offset:20480
    ds_read_b64_tr_b16 v[126:127], v23 offset:20736
    s_max_u32 s97, s97, s11
    v_lshl_add_u32 v39, v1, 1, s7
    s_lshr_b32 s9, s6, 1
    s_mul_i32 s9, s9, 11
    s_waitcnt lgkmcnt(6)
    v_mfma_f32_32x32x16_bf16 v[64:79], v[112:115], v[144:147], v[64:79]
    ds_read_b64_tr_b16 v[96:97], v24 offset:16384
    ds_read_b64_tr_b16 v[98:99], v24 offset:16640
    s_add_u32 m0, s90, 57344
    s_mul_i32 s22, s28, s82
    buffer_load_dwordx4 v12, s[48:51], s22 offen lds
    s_and_b32 s11, s4, 14
    s_xor_b32 s9, s9, s11
    s_xor_b32 s9, s9, 2
    v_lshl_add_u32 v39, v39, 4, s9
    s_waitcnt lgkmcnt(6)
    v_mfma_f32_32x32x16_bf16 v[80:95], v[116:119], v[144:147], v[80:95]
    ds_read_b64_tr_b16 v[100:101], v24 offset:20480
    ds_read_b64_tr_b16 v[102:103], v24 offset:20736
    v_smfmac_f32_16x16x64_bf16 v[30:33], v[60:63], v[112:119], v28
    v_lshlrev_b32 v39, 7, v39
    v_lshl_add_u32 v40, s3, 4, v1
    v_lshlrev_b32 v40, 7, v40
    s_cmp_eq_u32 s5, 0
    s_cselect_b32 s32, 0xffff, 1
    s_waitcnt lgkmcnt(6)
    v_mfma_f32_32x32x16_bf16 v[64:79], v[120:123], v[148:151], v[64:79]
    ds_read_b64_tr_b16 v[104:105], v25 offset:16384
    ds_read_b64_tr_b16 v[106:107], v25 offset:16640
    s_mov_b32 s33, 0
    s_cmp_eq_u32 s86, 4096
    s_cselect_b32 s100, 0, 1073741824
    s_lshl_b32 s81, s5, 11
    s_lshl4_add_u32 s87, s7, s4
    s_waitcnt lgkmcnt(6)
    v_mfma_f32_32x32x16_bf16 v[80:95], v[124:127], v[148:151], v[80:95]
    ds_read_b64_tr_b16 v[108:109], v25 offset:20480
    ds_read_b64_tr_b16 v[110:111], v25 offset:20736
    s_add_u32 m0, s90, 61440
    s_mul_i32 s22, s28, 1376
    buffer_load_dwordx4 v13, s[44:47], s22 offen lds
    s_lshr_b32 s9, s6, 1
    s_lshl1_add_u32 s87, s87, s9
    s_lshl1_add_u32 s87, s87, s83
    s_and_b32 s9, s6, 1
    s_waitcnt lgkmcnt(6)
    v_mfma_f32_32x32x16_bf16 v[64:79], v[96:99], v[152:155], v[64:79]
    s_waitcnt vmcnt(6)
    s_barrier
    v_add_u32 v22, 4294836224, v22
    ds_read_b64_tr_b16 v[112:113], v22 offset:40960
    ds_read_b64_tr_b16 v[114:115], v22 offset:41216
    s_lshl1_add_u32 s87, s87, s9
    s_lshl_b32 s87, s87, 11
    s_add_u32 s87, s87, 1048576
    v_add_u32 v45, s87, v4
    s_waitcnt lgkmcnt(6)
    v_mfma_f32_32x32x16_bf16 v[80:95], v[100:103], v[152:155], v[80:95]
    ds_read_b64_tr_b16 v[116:117], v22 offset:45056
    ds_read_b64_tr_b16 v[118:119], v22 offset:45312
    s_mov_b32 s84, 0xffff
    s_mov_b32 s85, 0xffff
    s_mov_b32 s58, 1409024
    s_mov_b32 s59, 0x20000
    s_waitcnt lgkmcnt(6)
    v_mfma_f32_32x32x16_bf16 v[64:79], v[104:107], v[156:159], v[64:79]
    v_add_u32 v23, 4294836224, v23
    ds_read_b64_tr_b16 v[120:121], v23 offset:40960
    ds_read_b64_tr_b16 v[122:123], v23 offset:41216
    s_add_u32 m0, s90, 16384
    s_mul_i32 s22, s29, s82
    buffer_load_dwordx4 v12, s[48:51], s22 offen lds
    s_mov_b32 s62, 524288
    s_mov_b32 s63, 0x20000
    s_mov_b32 s70, 1024
    s_mov_b32 s71, 0x20000
    s_waitcnt lgkmcnt(6)
    v_mfma_f32_32x32x16_bf16 v[80:95], v[108:111], v[156:159], v[80:95]
    ds_read_b64_tr_b16 v[124:125], v23 offset:45056
    ds_read_b64_tr_b16 v[126:127], v23 offset:45312
    s_mov_b32 s74, 2097152
L_page2:
    s_cbranch_execz L_it1
    s_mov_b32 s75, 0x20000
    s_bfe_u32 s9, s4, 0x10003
    s_bfe_u32 s17, s4, 0x30000
    s_waitcnt lgkmcnt(6)
    v_mfma_f32_32x32x16_bf16 v[64:79], v[112:115], v[160:163], v[64:79]
    v_add_u32 v24, 4294836224, v24
    ds_read_b64_tr_b16 v[96:97], v24 offset:40960
    ds_read_b64_tr_b16 v[98:99], v24 offset:41216
    s_lshl1_add_u32 s9, s3, s9
    s_and_b32 s12, s2, 7
    s_mul_i32 s12, s12, 5
    s_lshr_b32 s10, s3, 2
    s_waitcnt lgkmcnt(6)
    v_mfma_f32_32x32x16_bf16 v[80:95], v[116:119], v[160:163], v[80:95]
    ds_read_b64_tr_b16 v[100:101], v24 offset:45056
    ds_read_b64_tr_b16 v[102:103], v24 offset:45312
    v_smfmac_f32_16x16x64_bf16 v[30:33], v[60:63], v[112:119], v28
    s_add_u32 m0, s90, 20480
    s_mul_i32 s22, s29, 1376
    buffer_load_dwordx4 v13, s[44:47], s22 offen lds
    s_xor_b32 s10, s10, s17
    s_and_b32 s10, s10, 3
    s_lshl_b32 s20, s10, 16
    s_lshr_b32 s21, s20, 4
    s_waitcnt lgkmcnt(6)
    v_mfma_f32_32x32x16_bf16 v[64:79], v[120:123], v[164:167], v[64:79]
    v_add_u32 v25, 4294836224, v25
    ds_read_b64_tr_b16 v[104:105], v25 offset:40960
    ds_read_b64_tr_b16 v[106:107], v25 offset:41216
    s_lshr_b32 s0, s3, 2
    s_mul_i32 s0, s0, 2
    s_mul_i32 s1, s17, 1
    s_xor_b32 s0, s0, s1
    s_waitcnt lgkmcnt(6)
    v_mfma_f32_32x32x16_bf16 v[80:95], v[124:127], v[164:167], v[80:95]
    ds_read_b64_tr_b16 v[108:109], v25 offset:45056
    ds_read_b64_tr_b16 v[110:111], v25 offset:45312
    s_and_b32 s0, s0, 7
    s_lshl_b32 s1, s0, 12
    s_lshl_b32 s0, s0, 16
    s_and_b32 s12, s12, 15
    s_waitcnt lgkmcnt(6)
    v_mfma_f32_32x32x16_bf16 v[64:79], v[96:99], v[168:171], v[64:79]
    s_waitcnt vmcnt(5)
    s_barrier
    ds_read_b64_tr_b16 v[112:113], v22 offset:0
    ds_read_b64_tr_b16 v[114:115], v22 offset:256
    s_add_u32 m0, s90, 73728
    s_mul_i32 s22, s30, s82
    buffer_load_dwordx4 v12, s[48:51], s22 offen lds
    s_lshl_b32 s16, s12, 16
    s_lshr_b32 s18, s16, 4
    s_lshl_b32 s17, s17, 7
    v_lshl_add_u32 v46, v46, 10, s17
    s_waitcnt lgkmcnt(6)
    v_mfma_f32_32x32x16_bf16 v[80:95], v[100:103], v[168:171], v[80:95]
    ds_read_b64_tr_b16 v[116:117], v22 offset:4096
    ds_read_b64_tr_b16 v[118:119], v22 offset:4352
    v_add_u32 v44, v44, v46
    v_and_b32 v56, 7, v0
    v_lshl_add_u32 v46, v56, 4, v46
    v_lshl_add_u32 v46, s9, 16, v46
    s_waitcnt lgkmcnt(6)
    v_mfma_f32_32x32x16_bf16 v[64:79], v[104:107], v[172:175], v[64:79]
    ds_read_b64_tr_b16 v[120:121], v23 offset:0
    ds_read_b64_tr_b16 v[122:123], v23 offset:256
    s_and_b32 s11, s5, 1
    s_lshl1_add_u32 s9, s9, s11
    s_lshr_b32 s11, s5, 1
    s_mul_i32 s91, s9, 86
    s_waitcnt lgkmcnt(6)
    v_mfma_f32_32x32x16_bf16 v[80:95], v[108:111], v[172:175], v[80:95]
    ds_read_b64_tr_b16 v[124:125], v24 offset:0
    ds_read_b64_tr_b16 v[126:127], v24 offset:256
    s_add_u32 m0, s90, 77824
    s_mul_i32 s22, s30, 1376
    buffer_load_dwordx4 v13, s[44:47], s22 offen lds
    s_cmp_ge_u32 s11, 2
    s_cselect_b32 s101, 1073741824, 0
    s_add_u32 s101, s101, 86016
    s_add_u32 s91, s91, s11
    s_lshl_b32 s91, s91, 10
    s_waitcnt lgkmcnt(6)
    v_mfma_f32_32x32x16_bf16 v[64:79], v[112:115], v[176:179], v[64:79]
    ds_read_b64_tr_b16 v[96:97], v25 offset:0
    ds_read_b64_tr_b16 v[98:99], v25 offset:256
    s_add_u32 s91, s91, 7340032
    s_lshl_b32 s92, s9, 5
    s_add_u32 s92, s92, s11
    v_bfe_u32 v56, v0, 5, 1
    s_waitcnt lgkmcnt(6)
    v_mfma_f32_32x32x16_bf16 v[80:95], v[116:119], v[176:179], v[80:95]
    s_waitcnt vmcnt(4)
    s_barrier
    s_add_u32 s22, s86, 0
    buffer_store_dword v2, v5, s[52:55], s22 offen sc1
    ds_read_b64_tr_b16 v[100:101], v22 offset:57344
    ds_read_b64_tr_b16 v[102:103], v22 offset:57600
    v_smfmac_f32_16x16x64_bf16 v[30:33], v[60:63], v[112:119], v28
    v_bfe_u32 v57, v0, 2, 2
    v_lshl_add_u32 v56, v56, 2, v57
    v_lshl_add_u32 v56, s11, 4, v56
    v_bfe_u32 v57, v0, 3, 1
    s_waitcnt lgkmcnt(6)
    v_mfma_f32_32x32x16_bf16 v[64:79], v[120:123], v[180:183], v[64:79]
    ds_read_b64_tr_b16 v[104:105], v22 offset:61440
    ds_read_b64_tr_b16 v[106:107], v22 offset:61696
    s_add_u32 m0, s90, 40960
    s_mul_i32 s22, s31, s82
    buffer_load_dwordx4 v12, s[48:51], s22 offen lds
    v_lshl_add_u32 v52, v57, 6, v52
    v_lshl_add_u32 v52, v56, 7, v52
    v_xor_b32 v53, 64, v52
    v_and_b32 v9, 27, v1
    v_cmp_eq_u32 vcc, 16, v9
    v_mov_b32 v18, 0xdddddddd
    s_waitcnt lgkmcnt(6)
    v_mfma_f32_32x32x16_bf16 v[64:79], v[124:127], v[184:187], v[64:79]
    ds_read_b64_tr_b16 v[108:109], v23 offset:57344
    ds_read_b64_tr_b16 v[110:111], v23 offset:57600
    v_add_u32 v19, s91, v4
    v_cndmask_b32 v128, 0, v6, vcc
    v_add_u32 v20, 106496, v41
    s_waitcnt lgkmcnt(6)
    v_mfma_f32_32x32x16_bf16 v[64:79], v[96:99], v[188:191], v[64:79]
    ds_read_b64_tr_b16 v[112:113], v24 offset:57344
    ds_read_b64_tr_b16 v[114:115], v24 offset:57600
    v_xor_b32 v16, 1024, v41
    v_and_b32 v21, 4294959103, v42
    v_lshl_or_b32 v26, v26, 16, v26
    s_waitcnt lgkmcnt(6)
    v_mfma_f32_32x32x16_bf16 v[64:79], v[100:103], v[192:195], v[64:79]
    ds_read_b64_tr_b16 v[116:117], v25 offset:57344
    ds_read_b64_tr_b16 v[118:119], v25 offset:57600
    s_add_u32 m0, s90, 45056
    s_mul_i32 s22, s31, 1376
    buffer_load_dwordx4 v13, s[44:47], s22 offen lds
    v_lshl_or_b32 v27, v27, 16, v27
    v_mul_f32 v9, 0x3eb8aa3b, v8
    v_mov_b32 v129, v128
    s_waitcnt lgkmcnt(6)
    v_mfma_f32_32x32x16_bf16 v[80:95], v[104:107], v[192:195], v[80:95]
    s_waitcnt vmcnt(5)
    s_barrier
    ds_read_b64_tr_b16 v[120:121], v22 offset:16384
    ds_read_b64_tr_b16 v[122:123], v22 offset:16640
    v_smfmac_f32_16x16x64_bf16 v[30:33], v[60:63], v[100:107], v28
    v_mov_b32 v130, v128
    v_mov_b32 v131, v128
    v_mov_b32 v132, v128
    s_waitcnt lgkmcnt(6)
    v_mfma_f32_32x32x16_bf16 v[64:79], v[108:111], v[196:199], v[64:79]
    ds_read_b64_tr_b16 v[124:125], v22 offset:20480
    ds_read_b64_tr_b16 v[126:127], v22 offset:20736
    v_mov_b32 v133, v128
    v_mov_b32 v134, v128
    v_mov_b32 v135, v128
    s_waitcnt lgkmcnt(6)
    v_mfma_f32_32x32x16_bf16 v[64:79], v[112:115], v[200:203], v[64:79]
    ds_read_b64_tr_b16 v[96:97], v23 offset:16384
    ds_read_b64_tr_b16 v[98:99], v23 offset:16640
    v_mov_b32 v136, v128
    v_mov_b32 v137, v128
    v_mov_b32 v138, v128
    s_waitcnt lgkmcnt(6)
    v_mfma_f32_32x32x16_bf16 v[64:79], v[116:119], v[204:207], v[64:79]
    ds_read_b64_tr_b16 v[100:101], v24 offset:16384
    ds_read_b64_tr_b16 v[102:103], v24 offset:16640
    s_lshl3_add_u32 s22, s2, s5
    s_lshl_b32 s22, s22, 10
    v_lshlrev_b32 v54, 7, v1
    s_sub_u32 s23, s22, 1409024
    s_cselect_b32 s22, s22, s23
    s_cselect_b64 s[76:77], s[56:57], s[60:61]
    s_cselect_b32 s78, s58, s62
    s_mov_b32 s79, 0x20000
    s_mov_b64 exec, 0xff
    buffer_load_dword v55, v54, s[76:79], s22 offen
    s_mov_b64 exec, -1
    v_mov_b32 v139, v128
    v_mov_b32 v140, v128
    v_mov_b32 v141, v128
    s_waitcnt lgkmcnt(6)
    v_mfma_f32_32x32x16_bf16 v[64:79], v[120:123], v[208:211], v[64:79]
    ds_read_b64_tr_b16 v[104:105], v25 offset:16384
    ds_read_b64_tr_b16 v[106:107], v25 offset:16640
    s_add_u32 s22, s19, 1024
    s_add_u32 s23, s86, 32768
    s_cmp_eq_u32 s7, 0
    s_cselect_b32 s22, s22, s23
    s_mov_b64 exec, 1
    buffer_load_dword v55, v4, s[52:55], s22 offen sc1
    s_mov_b64 exec, -1
    v_mov_b32 v142, v128
    v_mov_b32 v143, v128
    v_mov_b32 v144, 0
    s_waitcnt lgkmcnt(6)
    v_mfma_f32_32x32x16_bf16 v[80:95], v[124:127], v[208:211], v[80:95]
    s_waitcnt vmcnt(5)
    s_barrier
    v_add_u32 v22, 16384, v22
    ds_read_b64_tr_b16 v[108:109], v22 offset:57344
    ds_read_b64_tr_b16 v[110:111], v22 offset:57600
    v_smfmac_f32_16x16x64_bf16 v[30:33], v[60:63], v[120:127], v28
    v_mov_b32 v145, 0
    v_mov_b32 v146, 0
    v_mov_b32 v147, 0
    s_waitcnt lgkmcnt(6)
    v_mfma_f32_32x32x16_bf16 v[64:79], v[96:99], v[212:215], v[64:79]
    ds_read_b64_tr_b16 v[112:113], v22 offset:61440
    ds_read_b64_tr_b16 v[114:115], v22 offset:61696
    v_mov_b32 v148, 0
    v_mov_b32 v149, 0
    v_mov_b32 v150, 0
    s_waitcnt lgkmcnt(6)
    v_mfma_f32_32x32x16_bf16 v[64:79], v[100:103], v[216:219], v[64:79]
    v_add_u32 v23, 16384, v23
    ds_read_b64_tr_b16 v[116:117], v23 offset:57344
    ds_read_b64_tr_b16 v[118:119], v23 offset:57600
    v_mov_b32 v151, 0
    v_mov_b32 v152, 0
    v_mov_b32 v153, 0
    s_waitcnt lgkmcnt(6)
    v_mfma_f32_32x32x16_bf16 v[64:79], v[104:107], v[220:223], v[64:79]
    v_add_u32 v24, 16384, v24
    ds_read_b64_tr_b16 v[120:121], v24 offset:57344
    ds_read_b64_tr_b16 v[122:123], v24 offset:57600
    v_mov_b32 v154, 0
    v_mov_b32 v155, 0
    v_mov_b32 v156, 0
    s_waitcnt lgkmcnt(6)
    v_mfma_f32_32x32x16_bf16 v[64:79], v[108:111], v[224:227], v[64:79]
    v_add_u32 v25, 16384, v25
    ds_read_b64_tr_b16 v[124:125], v25 offset:57344
    ds_read_b64_tr_b16 v[126:127], v25 offset:57600
    v_mov_b32 v157, 0
    v_mov_b32 v158, 0
    v_mov_b32 v159, 0
    s_waitcnt lgkmcnt(6)
    v_mfma_f32_32x32x16_bf16 v[80:95], v[112:115], v[224:227], v[80:95]
    s_waitcnt vmcnt(2)
    s_barrier
    ds_read_b64_tr_b16 v[96:97], v22 offset:24576
    ds_read_b64_tr_b16 v[98:99], v22 offset:24832
    v_smfmac_f32_16x16x64_bf16 v[30:33], v[60:63], v[108:115], v28
    v_mov_b32 v160, 0
    v_mov_b32 v161, 0
    v_mov_b32 v162, 0
    s_waitcnt lgkmcnt(6)
    v_mfma_f32_32x32x16_bf16 v[64:79], v[116:119], v[228:231], v[64:79]
    ds_read_b64_tr_b16 v[100:101], v22 offset:28672
    ds_read_b64_tr_b16 v[102:103], v22 offset:28928
    v_mov_b32 v163, 0
    v_mov_b32 v164, 0
    v_mov_b32 v165, 0
    s_waitcnt lgkmcnt(6)
    v_mfma_f32_32x32x16_bf16 v[64:79], v[120:123], v[232:235], v[64:79]
    ds_read_b64_tr_b16 v[104:105], v23 offset:24576
    ds_read_b64_tr_b16 v[106:107], v23 offset:24832
    s_mov_b32 s22, 4096
    s_mov_b64 exec, 255
    buffer_load_dword v54, v39, s[52:55], s22 offen sc1
    s_mov_b64 exec, -1
    v_mov_b32 v166, 0
    v_mov_b32 v167, 0
    s_waitcnt lgkmcnt(6)
    v_mfma_f32_32x32x16_bf16 v[64:79], v[124:127], v[236:239], v[64:79]
    ds_read_b64_tr_b16 v[108:109], v24 offset:24576
    ds_read_b64_tr_b16 v[110:111], v24 offset:24832
    v_mov_b32 v168, 0
    v_mov_b32 v169, 0
    s_waitcnt lgkmcnt(6)
    v_mfma_f32_32x32x16_bf16 v[64:79], v[96:99], v[240:243], v[64:79]
    ds_read_b64_tr_b16 v[112:113], v25 offset:24576
    ds_read_b64_tr_b16 v[114:115], v25 offset:24832
    v_mov_b32 v170, 0
    v_mov_b32 v171, 0
    s_waitcnt lgkmcnt(6)
    v_mfma_f32_32x32x16_bf16 v[80:95], v[100:103], v[240:243], v[80:95]
    v_add_u32 v23, 4294950912, v23
    ds_read_b64_tr_b16 v[116:117], v23 offset:4096
    ds_read_b64_tr_b16 v[118:119], v23 offset:4352
    v_smfmac_f32_16x16x64_bf16 v[30:33], v[60:63], v[96:103], v28
    v_mov_b32 v172, 0
    v_mov_b32 v173, 0
    s_waitcnt lgkmcnt(6)
    v_mfma_f32_32x32x16_bf16 v[64:79], v[104:107], v[244:247], v[64:79]
    v_add_u32 v24, 4294950912, v24
    ds_read_b64_tr_b16 v[120:121], v24 offset:4096
    ds_read_b64_tr_b16 v[122:123], v24 offset:4352
    v_mov_b32 v174, 0
    v_mov_b32 v175, 0
    s_waitcnt lgkmcnt(6)
    v_mfma_f32_32x32x16_bf16 v[64:79], v[108:111], v[248:251], v[64:79]
    v_add_u32 v25, 4294950912, v25
    ds_read_b64_tr_b16 v[124:125], v25 offset:4096
    ds_read_b64_tr_b16 v[126:127], v25 offset:4352
    v_add_f32 v30, v30, v31
    v_add_f32 v32, v32, v33
    ds_write_b32 v38, v30
    ds_write_b32 v38, v32 offset:512
    s_waitcnt lgkmcnt(8)
    v_mfma_f32_32x32x16_bf16 v[64:79], v[112:115], v[252:255], v[64:79]
    ds_read_b64_tr_b16 v[96:97], v23 offset:61440
    ds_read_b64_tr_b16 v[98:99], v23 offset:61696
    s_waitcnt lgkmcnt(2)
    s_barrier
    ds_read_b128 v[176:179], v37 offset:0
    ds_read_b128 v[192:195], v37 offset:512
    v_mfma_f32_32x32x16_bf16 v[80:95], v[116:119], v[180:183], v[80:95]
    ds_read_b64_tr_b16 v[100:101], v24 offset:61440
    ds_read_b64_tr_b16 v[102:103], v24 offset:61696
    v_and_b32 v10, v7, v6
    v_xor_b32 v12, v10, v6
    v_mov_b32 v11, 0
    v_mov_b32 v13, 0
    v_mov_b32 v14, 0
    v_mfma_f32_32x32x16_bf16 v[80:95], v[120:123], v[184:187], v[80:95]
    ds_read_b64_tr_b16 v[104:105], v25 offset:61440
    ds_read_b64_tr_b16 v[106:107], v25 offset:61696
    s_waitcnt vmcnt(0)
    v_cmp_ne_u32 vcc, v54, v2
    s_and_b32 s22, vcc_lo, 3
    s_cbranch_scc1 L_spin_7
L_back_8:
    s_add_u32 m0, s81, 98304
    s_mov_b32 s22, 0
    buffer_load_dwordx4 v45, s[52:55], s22 offen offset:0 sc1 lds
    buffer_load_dwordx4 v45, s[52:55], s22 offen offset:1024 sc1 lds
    v_mov_b32 v15, 0
    v_mov_b32 v35, 0
    v_mov_b32 v36, 0
    v_mov_b32 v37, 0
    s_waitcnt lgkmcnt(5)
    v_add_f32 v176, v176, v177
    v_add_f32 v178, v178, v179
    v_mov_b32 v58, v26
    v_add_f32 v176, v176, v178
    v_mov_b32 v59, 0
    v_cvt_pk_bf16_f32 v56, v176, v176
    v_and_b32 v177, s15, v56
    v_sub_f32 v177, v176, v177
    v_cvt_pk_bf16_f32 v57, v177, 0
    v_mfma_f32_32x32x16_bf16 v[80:95], v[124:127], v[188:191], v[80:95]
    ds_read_b64_tr_b16 v[108:109], v23 offset:20480
    ds_read_b64_tr_b16 v[110:111], v23 offset:20736
    s_add_u32 m0, s81, 114688
    s_mov_b32 s22, 524288
    buffer_load_dwordx4 v45, s[52:55], s22 offen offset:0 sc1 lds
    buffer_load_dwordx4 v45, s[52:55], s22 offen offset:1024 sc1 lds
    v_mfma_f32_32x32x16_bf16 v[64:79], v[56:59], v[48:51], v[64:79]
    s_waitcnt lgkmcnt(6)
    v_add_f32 v192, v192, v193
    v_add_f32 v194, v194, v195
    v_mov_b32 v62, v27
    v_add_f32 v192, v192, v194
    v_mov_b32 v63, 0
    v_cvt_pk_bf16_f32 v60, v192, v192
    v_and_b32 v193, s15, v60
    v_sub_f32 v193, v192, v193
    v_cvt_pk_bf16_f32 v61, v193, 0
    v_mfma_f32_32x32x16_bf16 v[80:95], v[96:99], v[196:199], v[80:95]
    ds_read_b64_tr_b16 v[112:113], v24 offset:20480
    ds_read_b64_tr_b16 v[114:115], v24 offset:20736
    v_mfma_f32_32x32x16_bf16 v[80:95], v[60:63], v[48:51], v[80:95]
    s_cmp_eq_u32 s7, 0
    s_cbranch_scc1 L_s2_Q
    s_waitcnt lgkmcnt(6)
    v_mfma_f32_32x32x16_bf16 v[80:95], v[100:103], v[200:203], v[80:95]
    ds_read_b64_tr_b16 v[116:117], v25 offset:20480
    ds_read_b64_tr_b16 v[118:119], v25 offset:20736
    v_mul_f32 v64, v8, v64
    v_mul_f32 v65, v8, v65
    v_mul_f32 v66, v8, v66
    v_mul_f32 v67, v8, v67
    v_mul_f32 v68, v8, v68
    v_mul_f32 v69, v8, v69
    v_mul_f32 v70, v8, v70
    s_waitcnt lgkmcnt(6)
    v_mfma_f32_32x32x16_bf16 v[80:95], v[104:107], v[204:207], v[80:95]
    v_add_u32 v23, 16384, v23
    ds_read_b64_tr_b16 v[120:121], v23 offset:61440
    ds_read_b64_tr_b16 v[122:123], v23 offset:61696
    v_mul_f32 v71, v8, v71
    v_max_f32 v64, 0, v64
    v_max_f32 v65, 0, v65
    v_max_f32 v66, 0, v66
    v_max_f32 v67, 0, v67
    v_max_f32 v68, 0, v68
    v_max_f32 v69, 0, v69
    s_waitcnt lgkmcnt(6)
    v_mfma_f32_32x32x16_bf16 v[80:95], v[108:111], v[212:215], v[80:95]
    v_add_u32 v24, 16384, v24
    ds_read_b64_tr_b16 v[124:125], v24 offset:61440
    ds_read_b64_tr_b16 v[126:127], v24 offset:61696
    v_max_f32 v70, 0, v70
    v_max_f32 v71, 0, v71
    v_mul_f32 v64, v64, v64
    v_mul_f32 v65, v65, v65
    v_mul_f32 v66, v66, v66
    v_mul_f32 v67, v67, v67
    v_mul_f32 v68, v68, v68
    s_waitcnt lgkmcnt(6)
    v_mfma_f32_32x32x16_bf16 v[80:95], v[112:115], v[216:219], v[80:95]
    v_add_u32 v25, 16384, v25
    ds_read_b64_tr_b16 v[96:97], v25 offset:61440
    ds_read_b64_tr_b16 v[98:99], v25 offset:61696
    v_mul_f32 v69, v69, v69
    v_mul_f32 v70, v70, v70
    v_mul_f32 v71, v71, v71
    v_cvt_pk_bf16_f32 v64, v64, v65
    v_cvt_pk_bf16_f32 v65, v66, v67
    v_cvt_pk_bf16_f32 v66, v68, v69
    v_cvt_pk_bf16_f32 v67, v70, v71
    s_waitcnt lgkmcnt(6)
    v_mfma_f32_32x32x16_bf16 v[80:95], v[116:119], v[220:223], v[80:95]
    ds_read_b64_tr_b16 v[100:101], v23 offset:28672
    ds_read_b64_tr_b16 v[102:103], v23 offset:28928
    v_mul_f32 v72, v8, v72
    v_mul_f32 v73, v8, v73
    v_mul_f32 v74, v8, v74
    v_mul_f32 v75, v8, v75
    v_mul_f32 v76, v8, v76
    v_mul_f32 v77, v8, v77
    v_mul_f32 v78, v8, v78
    s_waitcnt lgkmcnt(6)
    v_mfma_f32_32x32x16_bf16 v[80:95], v[120:123], v[228:231], v[80:95]
    ds_read_b64_tr_b16 v[104:105], v24 offset:28672
    ds_read_b64_tr_b16 v[106:107], v24 offset:28928
    v_mul_f32 v79, v8, v79
    v_max_f32 v72, 0, v72
    v_max_f32 v73, 0, v73
    v_max_f32 v74, 0, v74
    v_max_f32 v75, 0, v75
    v_max_f32 v76, 0, v76
    v_max_f32 v77, 0, v77
    s_waitcnt lgkmcnt(6)
    v_mfma_f32_32x32x16_bf16 v[80:95], v[124:127], v[232:235], v[80:95]
    ds_read_b64_tr_b16 v[108:109], v25 offset:28672
    ds_read_b64_tr_b16 v[110:111], v25 offset:28928
    v_max_f32 v78, 0, v78
    v_max_f32 v79, 0, v79
    v_mul_f32 v72, v72, v72
    v_mul_f32 v73, v73, v73
    v_mul_f32 v74, v74, v74
    v_mul_f32 v75, v75, v75
    v_mul_f32 v76, v76, v76
    s_waitcnt lgkmcnt(6)
    v_mfma_f32_32x32x16_bf16 v[80:95], v[96:99], v[236:239], v[80:95]
    v_mul_f32 v77, v77, v77
    v_mul_f32 v78, v78, v78
    v_mul_f32 v79, v79, v79
    v_cvt_pk_bf16_f32 v72, v72, v73
    v_cvt_pk_bf16_f32 v73, v74, v75
    v_cvt_pk_bf16_f32 v74, v76, v77
    v_cvt_pk_bf16_f32 v75, v78, v79
    s_waitcnt vmcnt(0)
    s_barrier
    s_waitcnt lgkmcnt(4)
    v_mfma_f32_32x32x16_bf16 v[80:95], v[100:103], v[244:247], v[80:95]
    s_waitcnt lgkmcnt(2)
    v_mfma_f32_32x32x16_bf16 v[80:95], v[104:107], v[248:251], v[80:95]
    s_waitcnt lgkmcnt(0)
    v_mfma_f32_32x32x16_bf16 v[80:95], v[108:111], v[252:255], v[80:95]
    s_setprio 2
    v_lshlrev_b32 v16, 11, v1
    v_xor_b32 v16, s19, v16
    s_nop 8
    v_pk_mul_f32 v[80:81], v[80:81], v[8:9] op_sel_hi:[1,0]
    v_pk_mul_f32 v[82:83], v[82:83], v[8:9] op_sel_hi:[1,0]
    v_pk_mul_f32 v[84:85], v[84:85], v[8:9] op_sel_hi:[1,0]
    v_pk_mul_f32 v[86:87], v[86:87], v[8:9] op_sel_hi:[1,0]
    v_max_f32 v80, 0, v80
    v_max_f32 v81, 0, v81
    v_max_f32 v82, 0, v82
    v_max_f32 v83, 0, v83
    v_max_f32 v84, 0, v84
    v_max_f32 v85, 0, v85
    v_max_f32 v86, 0, v86
    v_max_f32 v87, 0, v87
    v_pk_mul_f32 v[80:81], v[80:81], v[80:81]
    v_pk_mul_f32 v[82:83], v[82:83], v[82:83]
    v_pk_mul_f32 v[84:85], v[84:85], v[84:85]
    v_pk_mul_f32 v[86:87], v[86:87], v[86:87]
    v_cvt_pk_bf16_f32 v80, v80, v81
    v_cvt_pk_bf16_f32 v81, v82, v83
    v_cvt_pk_bf16_f32 v82, v84, v85
    v_cvt_pk_bf16_f32 v83, v86, v87
    v_pk_mul_f32 v[88:89], v[88:89], v[8:9] op_sel_hi:[1,0]
    v_pk_mul_f32 v[90:91], v[90:91], v[8:9] op_sel_hi:[1,0]
    v_pk_mul_f32 v[92:93], v[92:93], v[8:9] op_sel_hi:[1,0]
    v_pk_mul_f32 v[94:95], v[94:95], v[8:9] op_sel_hi:[1,0]
    v_max_f32 v88, 0, v88
    v_max_f32 v89, 0, v89
    v_max_f32 v90, 0, v90
    v_max_f32 v91, 0, v91
    v_max_f32 v92, 0, v92
    v_max_f32 v93, 0, v93
    v_max_f32 v94, 0, v94
    v_max_f32 v95, 0, v95
    v_pk_mul_f32 v[88:89], v[88:89], v[88:89]
    v_pk_mul_f32 v[90:91], v[90:91], v[90:91]
    v_pk_mul_f32 v[92:93], v[92:93], v[92:93]
    v_pk_mul_f32 v[94:95], v[94:95], v[94:95]
    v_cvt_pk_bf16_f32 v88, v88, v89
    v_cvt_pk_bf16_f32 v89, v90, v91
    v_cvt_pk_bf16_f32 v90, v92, v93
    v_cvt_pk_bf16_f32 v91, v94, v95
    s_mov_b64 exec, 0
    s_cmp_eq_u32 s5, 4
    s_cbranch_scc1 L_page4
    s_cmp_eq_u32 s5, 5
    s_cbranch_scc1 L_page5
L_it2:
    s_mov_b64 exec, -1
    s_mov_b32 s93, 200000
L_qw_10:
    s_mov_b64 exec, 3
    buffer_load_dword v55, v16, s[52:55], 0 offen offset:1024 sc1
    s_mov_b64 exec, -1
    s_waitcnt vmcnt(0)
    v_cmp_ne_u32 vcc, v55, v2
    s_and_b32 s22, vcc_lo, 3
    s_cbranch_scc0 L_qok_11
    s_sleep 4
    s_sub_u32 s93, s93, 1
    s_cbranch_scc0 L_qw_10
L_qok_11:
    s_xor_b32 s23, s19, 2048
    buffer_load_dwordx4 v[180:183], v4, s[52:55], s19 offen sc1
    buffer_load_dwordx4 v[176:179], v4, s[52:55], s23 offen sc1
    ds_read_b128 v[188:191], v21
    buffer_store_dwordx4 v[64:67], v4, s[52:55], s96 offen offset:0 sc1
    buffer_store_dwordx4 v[72:75], v4, s[52:55], s96 offen offset:1024 sc1
    s_waitcnt vmcnt(2) lgkmcnt(0)
    s_branch L_s2_J
L_s2_Q:
    s_setprio 1
    s_waitcnt lgkmcnt(6)
    v_mfma_f32_32x32x16_bf16 v[80:95], v[100:103], v[200:203], v[80:95]
    ds_read_b64_tr_b16 v[116:117], v25 offset:20480
    ds_read_b64_tr_b16 v[118:119], v25 offset:20736
    v_mul_f32 v64, v9, v64
    v_mul_f32 v65, v9, v65
    v_mul_f32 v66, v9, v66
    v_mul_f32 v67, v9, v67
    v_mul_f32 v68, v9, v68
    v_mul_f32 v69, v9, v69
    v_mul_f32 v70, v9, v70
    s_waitcnt lgkmcnt(6)
    v_mfma_f32_32x32x16_bf16 v[80:95], v[104:107], v[204:207], v[80:95]
    v_add_u32 v23, 16384, v23
    ds_read_b64_tr_b16 v[120:121], v23 offset:61440
    ds_read_b64_tr_b16 v[122:123], v23 offset:61696
    v_mul_f32 v71, v9, v71
    v_cvt_pk_bf16_f32 v64, v64, v65
    v_cvt_pk_bf16_f32 v65, v66, v67
    v_cvt_pk_bf16_f32 v66, v68, v69
    v_cvt_pk_bf16_f32 v67, v70, v71
    buffer_store_dwordx4 v[64:67], v4, s[52:55], s19 offen sc1
    v_mul_f32 v72, v9, v72
    s_waitcnt lgkmcnt(6)
    v_mfma_f32_32x32x16_bf16 v[80:95], v[108:111], v[212:215], v[80:95]
    v_add_u32 v24, 16384, v24
    ds_read_b64_tr_b16 v[124:125], v24 offset:61440
    ds_read_b64_tr_b16 v[126:127], v24 offset:61696
    v_mul_f32 v73, v9, v73
    v_mul_f32 v74, v9, v74
    v_mul_f32 v75, v9, v75
    v_mul_f32 v76, v9, v76
    v_mul_f32 v77, v9, v77
    v_mul_f32 v78, v9, v78
    v_mul_f32 v79, v9, v79
    s_waitcnt lgkmcnt(6)
    v_mfma_f32_32x32x16_bf16 v[80:95], v[112:115], v[216:219], v[80:95]
    v_add_u32 v25, 16384, v25
    ds_read_b64_tr_b16 v[96:97], v25 offset:61440
    ds_read_b64_tr_b16 v[98:99], v25 offset:61696
    v_cvt_pk_bf16_f32 v72, v72, v73
    v_cvt_pk_bf16_f32 v73, v74, v75
    v_cvt_pk_bf16_f32 v74, v76, v77
    v_cvt_pk_bf16_f32 v75, v78, v79
    ds_write_b128 v41, v[72:75]
    s_waitcnt lgkmcnt(7)
    v_mfma_f32_32x32x16_bf16 v[80:95], v[116:119], v[220:223], v[80:95]
    ds_read_b64_tr_b16 v[100:101], v23 offset:28672
    ds_read_b64_tr_b16 v[102:103], v23 offset:28928
    s_waitcnt lgkmcnt(7)
    v_mfma_f32_32x32x16_bf16 v[80:95], v[120:123], v[228:231], v[80:95]
    ds_read_b64_tr_b16 v[104:105], v24 offset:28672
    ds_read_b64_tr_b16 v[106:107], v24 offset:28928
    s_waitcnt lgkmcnt(7)
    v_mfma_f32_32x32x16_bf16 v[80:95], v[124:127], v[232:235], v[80:95]
    ds_read_b64_tr_b16 v[108:109], v25 offset:28672
    ds_read_b64_tr_b16 v[110:111], v25 offset:28928
    s_waitcnt lgkmcnt(7)
    v_mfma_f32_32x32x16_bf16 v[80:95], v[96:99], v[236:239], v[80:95]
    s_waitcnt lgkmcnt(4)
    v_mfma_f32_32x32x16_bf16 v[80:95], v[100:103], v[244:247], v[80:95]
    s_waitcnt lgkmcnt(2)
    v_mfma_f32_32x32x16_bf16 v[80:95], v[104:107], v[248:251], v[80:95]
    s_waitcnt lgkmcnt(0)
    v_mfma_f32_32x32x16_bf16 v[80:95], v[108:111], v[252:255], v[80:95]
    s_setprio 1
    s_nop 10
    v_pk_mul_f32 v[80:81], v[80:81], v[8:9] op_sel_hi:[1,0]
    v_pk_mul_f32 v[82:83], v[82:83], v[8:9] op_sel_hi:[1,0]
    v_pk_mul_f32 v[84:85], v[84:85], v[8:9] op_sel_hi:[1,0]
    v_pk_mul_f32 v[86:87], v[86:87], v[8:9] op_sel_hi:[1,0]
    v_max_f32 v80, 0, v80
    v_max_f32 v81, 0, v81
    v_max_f32 v82, 0, v82
    v_max_f32 v83, 0, v83
    v_max_f32 v84, 0, v84
    v_max_f32 v85, 0, v85
    v_max_f32 v86, 0, v86
    v_max_f32 v87, 0, v87
    v_pk_mul_f32 v[80:81], v[80:81], v[80:81]
    v_pk_mul_f32 v[82:83], v[82:83], v[82:83]
    v_pk_mul_f32 v[84:85], v[84:85], v[84:85]
    v_pk_mul_f32 v[86:87], v[86:87], v[86:87]
    v_cvt_pk_bf16_f32 v80, v80, v81
    v_cvt_pk_bf16_f32 v81, v82, v83
    v_cvt_pk_bf16_f32 v82, v84, v85
    v_cvt_pk_bf16_f32 v83, v86, v87
    v_pk_mul_f32 v[88:89], v[88:89], v[8:9] op_sel_hi:[1,0]
    v_pk_mul_f32 v[90:91], v[90:91], v[8:9] op_sel_hi:[1,0]
    v_pk_mul_f32 v[92:93], v[92:93], v[8:9] op_sel_hi:[1,0]
    v_pk_mul_f32 v[94:95], v[94:95], v[8:9] op_sel_hi:[1,0]
    v_max_f32 v88, 0, v88
    v_max_f32 v89, 0, v89
    v_max_f32 v90, 0, v90
    v_max_f32 v91, 0, v91
    v_max_f32 v92, 0, v92
    v_max_f32 v93, 0, v93
    v_max_f32 v94, 0, v94
    v_max_f32 v95, 0, v95
    v_pk_mul_f32 v[88:89], v[88:89], v[88:89]
    v_pk_mul_f32 v[90:91], v[90:91], v[90:91]
    v_pk_mul_f32 v[92:93], v[92:93], v[92:93]
    v_pk_mul_f32 v[94:95], v[94:95], v[94:95]
    v_cvt_pk_bf16_f32 v88, v88, v89
    v_cvt_pk_bf16_f32 v89, v90, v91
    v_cvt_pk_bf16_f32 v90, v92, v93
    v_cvt_pk_bf16_f32 v91, v94, v95
    s_waitcnt vmcnt(0)
    s_mov_b64 exec, 1
    buffer_store_dword v2, v4, s[52:55], s19 offen offset:1024 sc1
    s_mov_b64 exec, -1
    s_barrier
    ds_read_b128 v[188:191], v21
    ds_read_b128 v[176:179], v16
    ds_read_b128 v[180:183], v41
L_s2_J:
    ds_read_b128 v[184:187], v42 offset:0
    s_mov_b64 exec, s[84:85]
    ds_read_b128 v[128:131], v43 offset:0
    ds_read_b128 v[132:135], v43 offset:512
    s_mov_b64 exec, -1
    s_waitcnt lgkmcnt(4)
    v_mfma_f32_32x32x16_bf16 v[192:207], v[188:191], v[176:179], 0
    s_waitcnt lgkmcnt(3)
    v_mfma_f32_32x32x16_bf16 v[208:223], v[188:191], v[180:183], 0
    s_nop 9
    v_max3_f32 v56, v192, v193, v194
    v_max3_f32 v57, v195, v196, v197
    v_max3_f32 v56, v56, v198, v199
    v_max3_f32 v57, v57, v200, v201
    v_max3_f32 v56, v56, v202, v203
    v_max3_f32 v57, v57, v204, v205
    v_max3_f32 v56, v56, v206, v207
    v_max_f32 v56, v56, v57
    v_max3_f32 v58, v208, v209, v210
    v_max3_f32 v59, v211, v212, v213
    v_max3_f32 v58, v58, v214, v215
    v_max3_f32 v59, v59, v216, v217
    v_max3_f32 v58, v58, v218, v219
    v_max3_f32 v59, v59, v220, v221
    v_max3_f32 v58, v58, v222, v223
    v_max_f32 v58, v58, v59
    s_nop 1
    v_permlane32_swap_b32 v56, v58
    v_max_f32 v56, v56, v58
    v_sub_f32 v56, 0xc2c40000, v56
    v_cvt_pk_bf16_f32 v34, v56, 0
L_page3:
    s_cbranch_execz L_it1
    s_waitcnt lgkmcnt(0)
    s_nop 0
    v_mfma_f32_32x32x16_bf16 v[224:239], v[10:13], v[34:37], 0
    v_mfma_f32_32x32x16_bf16 v[192:207], v[184:187], v[176:179], v[224:239]
    v_mfma_f32_32x32x16_bf16 v[240:255], v[12:15], v[34:37], 0
    s_nop 10
    v_exp_f32 v192, v192
    v_exp_f32 v193, v193
    s_mov_b64 exec, s[84:85]
    ds_read_b128 v[136:139], v43 offset:1024
    ds_read_b128 v[140:143], v43 offset:1536
    s_mov_b64 exec, -1
    v_exp_f32 v194, v194
    v_exp_f32 v195, v195
    v_exp_f32 v196, v196
    v_mfma_f32_32x32x16_bf16 v[208:223], v[184:187], v[180:183], v[240:255]
    ds_read_b128 v[188:191], v42 offset:1024
    v_exp_f32 v197, v197
    v_exp_f32 v198, v198
    v_exp_f32 v199, v199
    v_exp_f32 v200, v200
    v_exp_f32 v201, v201
    v_exp_f32 v202, v202
    v_smfmac_f32_32x32x32_bf16 v[144:159], v[128:131], v[192:199], v18
    v_exp_f32 v203, v203
    v_exp_f32 v204, v204
    v_exp_f32 v205, v205
    v_exp_f32 v206, v206
    v_exp_f32 v207, v207
    v_exp_f32 v208, v208
    v_exp_f32 v209, v209
    v_smfmac_f32_32x32x32_bf16 v[144:159], v[132:135], v[200:207], v18
    v_exp_f32 v210, v210
    v_exp_f32 v211, v211
    v_exp_f32 v212, v212
    s_waitcnt lgkmcnt(0)
    v_mfma_f32_32x32x16_bf16 v[192:207], v[188:191], v[176:179], v[224:239]
    v_exp_f32 v213, v213
    v_exp_f32 v214, v214
    v_exp_f32 v215, v215
    v_exp_f32 v216, v216
    v_exp_f32 v217, v217
    v_exp_f32 v218, v218
    v_smfmac_f32_32x32x32_bf16 v[160:175], v[128:131], v[208:215], v18
    v_exp_f32 v219, v219
    v_exp_f32 v220, v220
    v_exp_f32 v221, v221
    v_exp_f32 v222, v222
    v_exp_f32 v223, v223
    v_exp_f32 v192, v192
    v_exp_f32 v193, v193
    v_smfmac_f32_32x32x32_bf16 v[160:175], v[132:135], v[216:223], v18
    s_mov_b64 exec, s[84:85]
    ds_read_b128 v[128:131], v43 offset:2048
    ds_read_b128 v[132:135], v43 offset:2560
    s_mov_b64 exec, -1
    v_exp_f32 v194, v194
    v_exp_f32 v195, v195
    v_exp_f32 v196, v196
    v_mfma_f32_32x32x16_bf16 v[208:223], v[188:191], v[180:183], v[240:255]
    ds_read_b128 v[184:187], v42 offset:2048
    v_exp_f32 v197, v197
    v_exp_f32 v198, v198
    v_exp_f32 v199, v199
    v_exp_f32 v200, v200
    v_exp_f32 v201, v201
    v_exp_f32 v202, v202
    v_smfmac_f32_32x32x32_bf16 v[144:159], v[136:139], v[192:199], v18
    v_exp_f32 v203, v203
    v_exp_f32 v204, v204
    v_exp_f32 v205, v205
    v_exp_f32 v206, v206
    v_exp_f32 v207, v207
    v_exp_f32 v208, v208
    v_exp_f32 v209, v209
    v_smfmac_f32_32x32x32_bf16 v[144:159], v[140:143], v[200:207], v18
    v_exp_f32 v210, v210
    v_exp_f32 v211, v211
    v_exp_f32 v212, v212
    s_waitcnt lgkmcnt(0)
    v_mfma_f32_32x32x16_bf16 v[192:207], v[184:187], v[176:179], v[224:239]
    v_exp_f32 v213, v213
    v_exp_f32 v214, v214
    v_exp_f32 v215, v215
    v_exp_f32 v216, v216
    v_exp_f32 v217, v217
    v_exp_f32 v218, v218
    v_smfmac_f32_32x32x32_bf16 v[160:175], v[136:139], v[208:215], v18
    v_exp_f32 v219, v219
    v_exp_f32 v220, v220
    v_exp_f32 v221, v221
    v_exp_f32 v222, v222
    v_exp_f32 v223, v223
    v_exp_f32 v192, v192
    v_exp_f32 v193, v193
    v_smfmac_f32_32x32x32_bf16 v[160:175], v[140:143], v[216:223], v18
    s_mov_b64 exec, s[84:85]
    ds_read_b128 v[136:139], v43 offset:3072
    ds_read_b128 v[140:143], v43 offset:3584
    s_mov_b64 exec, -1
    v_exp_f32 v194, v194
    v_exp_f32 v195, v195
    v_exp_f32 v196, v196
    v_mfma_f32_32x32x16_bf16 v[208:223], v[184:187], v[180:183], v[240:255]
    ds_read_b128 v[188:191], v42 offset:3072
    v_exp_f32 v197, v197
    v_exp_f32 v198, v198
    v_exp_f32 v199, v199
    v_exp_f32 v200, v200
    v_exp_f32 v201, v201
    v_exp_f32 v202, v202
    v_smfmac_f32_32x32x32_bf16 v[144:159], v[128:131], v[192:199], v18
    v_exp_f32 v203, v203
    v_exp_f32 v204, v204
    v_exp_f32 v205, v205
    v_exp_f32 v206, v206
    v_exp_f32 v207, v207
    v_exp_f32 v208, v208
    v_exp_f32 v209, v209
    v_smfmac_f32_32x32x32_bf16 v[144:159], v[132:135], v[200:207], v18
    v_exp_f32 v210, v210
    v_exp_f32 v211, v211
    v_exp_f32 v212, v212
    s_waitcnt lgkmcnt(0)
    v_mfma_f32_32x32x16_bf16 v[192:207], v[188:191], v[176:179], v[224:239]
    v_cmp_ne_u32 vcc, v54, v2
    s_and_b32 s22, vcc_lo, 4
    s_cbranch_scc1 L_spin_12
L_back_13:
    s_add_u32 m0, s81, 131072
    s_mov_b32 s22, 1048576
    buffer_load_dwordx4 v45, s[52:55], s22 offen offset:0 sc1 lds
    buffer_load_dwordx4 v45, s[52:55], s22 offen offset:1024 sc1 lds
    v_exp_f32 v213, v213
    v_exp_f32 v214, v214
    v_exp_f32 v215, v215
    v_exp_f32 v216, v216
    v_exp_f32 v217, v217
    v_exp_f32 v218, v218
    v_smfmac_f32_32x32x32_bf16 v[160:175], v[128:131], v[208:215], v18
    v_exp_f32 v219, v219
    v_exp_f32 v220, v220
    v_exp_f32 v221, v221
    v_exp_f32 v222, v222
    v_exp_f32 v223, v223
    v_exp_f32 v192, v192
    v_exp_f32 v193, v193
    v_smfmac_f32_32x32x32_bf16 v[160:175], v[132:135], v[216:223], v18
    s_mov_b64 exec, s[84:85]
    ds_read_b128 v[128:131], v43 offset:16384
    ds_read_b128 v[132:135], v43 offset:16896
    s_mov_b64 exec, -1
    v_exp_f32 v194, v194
    v_exp_f32 v195, v195
    v_exp_f32 v196, v196
    v_mfma_f32_32x32x16_bf16 v[208:223], v[188:191], v[180:183], v[240:255]
    ds_read_b128 v[184:187], v42 offset:16384
    v_exp_f32 v197, v197
    v_exp_f32 v198, v198
    v_exp_f32 v199, v199
    v_exp_f32 v200, v200
    v_exp_f32 v201, v201
    v_exp_f32 v202, v202
    v_smfmac_f32_32x32x32_bf16 v[144:159], v[136:139], v[192:199], v18
    v_exp_f32 v203, v203
    v_exp_f32 v204, v204
    v_exp_f32 v205, v205
    v_exp_f32 v206, v206
    v_exp_f32 v207, v207
    v_exp_f32 v208, v208
    v_exp_f32 v209, v209
    v_smfmac_f32_32x32x32_bf16 v[144:159], v[140:143], v[200:207], v18
    v_exp_f32 v210, v210
    v_exp_f32 v211, v211
    v_exp_f32 v212, v212
    s_waitcnt lgkmcnt(0)
    v_mfma_f32_32x32x16_bf16 v[192:207], v[184:187], v[176:179], v[224:239]
    v_exp_f32 v213, v213
    v_exp_f32 v214, v214
    v_exp_f32 v215, v215
    v_exp_f32 v216, v216
    v_exp_f32 v217, v217
    v_exp_f32 v218, v218
    v_smfmac_f32_32x32x32_bf16 v[160:175], v[136:139], v[208:215], v18
    buffer_store_dwordx4 v[80:83], v4, s[52:55], s97 offen offset:0 sc1
    v_exp_f32 v219, v219
    v_exp_f32 v220, v220
    v_exp_f32 v221, v221
    v_exp_f32 v222, v222
    v_exp_f32 v223, v223
    v_exp_f32 v192, v192
    v_exp_f32 v193, v193
    v_smfmac_f32_32x32x32_bf16 v[160:175], v[140:143], v[216:223], v18
    s_mov_b64 exec, s[84:85]
    ds_read_b128 v[136:139], v43 offset:17408
    ds_read_b128 v[140:143], v43 offset:17920
    s_mov_b64 exec, -1
    v_exp_f32 v194, v194
    v_exp_f32 v195, v195
    v_exp_f32 v196, v196
    v_mfma_f32_32x32x16_bf16 v[208:223], v[184:187], v[180:183], v[240:255]
    ds_read_b128 v[188:191], v42 offset:17408
    v_exp_f32 v197, v197
    v_exp_f32 v198, v198
    v_exp_f32 v199, v199
    v_exp_f32 v200, v200
    v_exp_f32 v201, v201
    v_exp_f32 v202, v202
    v_smfmac_f32_32x32x32_bf16 v[144:159], v[128:131], v[192:199], v18
    v_exp_f32 v203, v203
    v_exp_f32 v204, v204
    v_exp_f32 v205, v205
    v_exp_f32 v206, v206
    v_exp_f32 v207, v207
    v_exp_f32 v208, v208
    v_exp_f32 v209, v209
    v_smfmac_f32_32x32x32_bf16 v[144:159], v[132:135], v[200:207], v18
    buffer_store_dwordx4 v[88:91], v4, s[52:55], s97 offen offset:1024 sc1
    v_exp_f32 v210, v210
    v_exp_f32 v211, v211
    v_exp_f32 v212, v212
    s_waitcnt lgkmcnt(0)
    v_mfma_f32_32x32x16_bf16 v[192:207], v[188:191], v[176:179], v[224:239]
    v_exp_f32 v213, v213
    v_exp_f32 v214, v214
    v_exp_f32 v215, v215
    v_exp_f32 v216, v216
    v_exp_f32 v217, v217
    v_exp_f32 v218, v218
    v_smfmac_f32_32x32x32_bf16 v[160:175], v[128:131], v[208:215], v18
    v_exp_f32 v219, v219
    v_exp_f32 v220, v220
    v_exp_f32 v221, v221
    v_exp_f32 v222, v222
    v_exp_f32 v223, v223
    v_exp_f32 v192, v192
    v_exp_f32 v193, v193
    v_smfmac_f32_32x32x32_bf16 v[160:175], v[132:135], v[216:223], v18
    s_mov_b64 exec, s[84:85]
    ds_read_b128 v[128:131], v43 offset:18432
    ds_read_b128 v[132:135], v43 offset:18944
    s_mov_b64 exec, -1
    v_exp_f32 v194, v194
    v_exp_f32 v195, v195
    v_exp_f32 v196, v196
    v_mfma_f32_32x32x16_bf16 v[208:223], v[188:191], v[180:183], v[240:255]
    ds_read_b128 v[184:187], v42 offset:18432
    v_exp_f32 v197, v197
    v_exp_f32 v198, v198
    v_exp_f32 v199, v199
    v_exp_f32 v200, v200
    v_exp_f32 v201, v201
    v_exp_f32 v202, v202
    v_smfmac_f32_32x32x32_bf16 v[144:159], v[136:139], v[192:199], v18
    v_exp_f32 v203, v203
    v_exp_f32 v204, v204
    v_exp_f32 v205, v205
    v_exp_f32 v206, v206
    v_exp_f32 v207, v207
    v_exp_f32 v208, v208
    v_exp_f32 v209, v209
    v_smfmac_f32_32x32x32_bf16 v[144:159], v[140:143], v[200:207], v18
    v_exp_f32 v210, v210
    v_exp_f32 v211, v211
    v_exp_f32 v212, v212
    s_waitcnt lgkmcnt(0)
    v_mfma_f32_32x32x16_bf16 v[192:207], v[184:187], v[176:179], v[224:239]
    v_exp_f32 v213, v213
    v_exp_f32 v214, v214
    v_exp_f32 v215, v215
    v_exp_f32 v216, v216
    v_exp_f32 v217, v217
    v_exp_f32 v218, v218
    v_smfmac_f32_32x32x32_bf16 v[160:175], v[136:139], v[208:215], v18
    v_exp_f32 v219, v219
    v_exp_f32 v220, v220
    v_exp_f32 v221, v221
    v_exp_f32 v222, v222
    v_exp_f32 v223, v223
    v_exp_f32 v192, v192
    v_exp_f32 v193, v193
    v_smfmac_f32_32x32x32_bf16 v[160:175], v[140:143], v[216:223], v18
    s_mov_b64 exec, s[84:85]
    ds_read_b128 v[136:139], v43 offset:19456
    ds_read_b128 v[140:143], v43 offset:19968
    s_mov_b64 exec, -1
    v_exp_f32 v194, v194
    v_exp_f32 v195, v195
    v_exp_f32 v196, v196
    v_mfma_f32_32x32x16_bf16 v[208:223], v[184:187], v[180:183], v[240:255]
    ds_read_b128 v[188:191], v42 offset:19456
    v_exp_f32 v197, v197
    v_exp_f32 v198, v198
    v_exp_f32 v199, v199
    v_exp_f32 v200, v200
    v_exp_f32 v201, v201
    v_exp_f32 v202, v202
    v_smfmac_f32_32x32x32_bf16 v[144:159], v[128:131], v[192:199], v18
    v_exp_f32 v203, v203
    v_exp_f32 v204, v204
    v_exp_f32 v205, v205
    v_exp_f32 v206, v206
    v_exp_f32 v207, v207
    s_setprio 0
    v_exp_f32 v208, v208
    v_exp_f32 v209, v209
    v_smfmac_f32_32x32x32_bf16 v[144:159], v[132:135], v[200:207], v18
    v_exp_f32 v210, v210
    v_exp_f32 v211, v211
    v_exp_f32 v212, v212
    s_waitcnt lgkmcnt(0)
    v_mfma_f32_32x32x16_bf16 v[192:207], v[188:191], v[176:179], v[224:239]
    v_exp_f32 v213, v213
    v_exp_f32 v214, v214
    v_exp_f32 v215, v215
    v_exp_f32 v216, v216
    v_exp_f32 v217, v217
    v_exp_f32 v218, v218
    v_smfmac_f32_32x32x32_bf16 v[160:175], v[128:131], v[208:215], v18
    v_exp_f32 v219, v219
    v_exp_f32 v220, v220
    v_exp_f32 v221, v221
    v_exp_f32 v222, v222
    v_exp_f32 v223, v223
    s_waitcnt vmcnt(0)
    s_barrier
    s_setprio 3
    v_exp_f32 v192, v192
    v_exp_f32 v193, v193
    v_smfmac_f32_32x32x32_bf16 v[160:175], v[132:135], v[216:223], v18
    s_mov_b64 exec, s[84:85]
    ds_read_b128 v[128:131], v43 offset:32768
    ds_read_b128 v[132:135], v43 offset:33280
    s_mov_b64 exec, -1
    v_exp_f32 v194, v194
    v_exp_f32 v195, v195
    v_exp_f32 v196, v196
    v_mfma_f32_32x32x16_bf16 v[208:223], v[188:191], v[180:183], v[240:255]
    ds_read_b128 v[184:187], v42 offset:32768
    v_exp_f32 v197, v197
    v_exp_f32 v198, v198
    v_exp_f32 v199, v199
    v_exp_f32 v200, v200
    v_exp_f32 v201, v201
    v_exp_f32 v202, v202
    v_smfmac_f32_32x32x32_bf16 v[144:159], v[136:139], v[192:199], v18
    s_add_u32 m0, s80, 49152
    s_xor_b32 s22, s20, 1048576
    buffer_load_dwordx4 v44, s[56:59], s22 offen  lds
    v_exp_f32 v203, v203
    v_exp_f32 v204, v204
    v_exp_f32 v205, v205
    v_exp_f32 v206, v206
    v_exp_f32 v207, v207
    v_exp_f32 v208, v208
    v_exp_f32 v209, v209
    v_smfmac_f32_32x32x32_bf16 v[144:159], v[140:143], v[200:207], v18
    s_add_u32 s22, s86, 32768
    buffer_store_dword v2, v5, s[52:55], s22 offen sc1
    v_cmp_ne_u32 vcc, v54, v2
    s_and_b32 s22, vcc_lo, 248
    s_cbranch_scc1 L_spin_15
L_back_16:
    s_add_u32 m0, s81, 147456
    s_mov_b32 s22, 1572864
    buffer_load_dwordx4 v45, s[52:55], s22 offen offset:0 sc1 lds
    v_exp_f32 v210, v210
    v_exp_f32 v211, v211
    v_exp_f32 v212, v212
    s_waitcnt lgkmcnt(0)
    v_mfma_f32_32x32x16_bf16 v[192:207], v[184:187], v[176:179], v[224:239]
    s_add_u32 m0, s80, 57344
    s_xor_b32 s22, s20, 1114112
    buffer_load_dwordx4 v44, s[56:59], s22 offen  lds
    v_exp_f32 v213, v213
    v_exp_f32 v214, v214
    v_exp_f32 v215, v215
    v_exp_f32 v216, v216
    v_exp_f32 v217, v217
    v_exp_f32 v218, v218
    v_smfmac_f32_32x32x32_bf16 v[160:175], v[136:139], v[208:215], v18
    v_exp_f32 v219, v219
    v_exp_f32 v220, v220
    v_exp_f32 v221, v221
    v_exp_f32 v222, v222
    v_exp_f32 v223, v223
    v_exp_f32 v192, v192
    v_exp_f32 v193, v193
    v_smfmac_f32_32x32x32_bf16 v[160:175], v[140:143], v[216:223], v18
    s_mov_b64 exec, s[84:85]
    ds_read_b128 v[136:139], v43 offset:33792
    ds_read_b128 v[140:143], v43 offset:34304
    s_mov_b64 exec, -1
    v_exp_f32 v194, v194
    v_exp_f32 v195, v195
    v_exp_f32 v196, v196
    v_mfma_f32_32x32x16_bf16 v[208:223], v[184:187], v[180:183], v[240:255]
    ds_read_b128 v[188:191], v42 offset:33792
    v_exp_f32 v197, v197
    v_exp_f32 v198, v198
    v_exp_f32 v199, v199
    v_exp_f32 v200, v200
    v_exp_f32 v201, v201
    v_exp_f32 v202, v202
    v_smfmac_f32_32x32x32_bf16 v[144:159], v[128:131], v[192:199], v18
    s_add_u32 m0, s80, 65536
    s_xor_b32 s22, s20, 1179648
    buffer_load_dwordx4 v44, s[56:59], s22 offen  lds
    v_exp_f32 v203, v203
    v_exp_f32 v204, v204
    v_exp_f32 v205, v205
    v_exp_f32 v206, v206
    v_exp_f32 v207, v207
    v_exp_f32 v208, v208
    v_exp_f32 v209, v209
    v_smfmac_f32_32x32x32_bf16 v[144:159], v[132:135], v[200:207], v18
    s_add_u32 m0, s81, 147456
    s_mov_b32 s22, 1572864
    buffer_load_dwordx4 v45, s[52:55], s22 offen offset:1024 sc1 lds
    v_exp_f32 v210, v210
    v_exp_f32 v211, v211
    v_exp_f32 v212, v212
    s_waitcnt lgkmcnt(0)
    v_mfma_f32_32x32x16_bf16 v[192:207], v[188:191], v[176:179], v[224:239]
    s_add_u32 m0, s80, 73728
    s_xor_b32 s22, s20, 1245184
    buffer_load_dwordx4 v44, s[56:59], s22 offen  lds
    v_exp_f32 v213, v213
    v_exp_f32 v214, v214
    v_exp_f32 v215, v215
    v_exp_f32 v216, v216
    v_exp_f32 v217, v217
    v_exp_f32 v218, v218
    v_smfmac_f32_32x32x32_bf16 v[160:175], v[128:131], v[208:215], v18
    v_exp_f32 v219, v219
    v_exp_f32 v220, v220
    v_exp_f32 v221, v221
    v_exp_f32 v222, v222
    v_exp_f32 v223, v223
    s_setprio 2
    v_exp_f32 v192, v192
    v_exp_f32 v193, v193
    v_smfmac_f32_32x32x32_bf16 v[160:175], v[132:135], v[216:223], v18
    s_mov_b64 exec, s[84:85]
    ds_read_b128 v[128:131], v43 offset:34816
    ds_read_b128 v[132:135], v43 offset:35328
    s_mov_b64 exec, -1
    v_exp_f32 v194, v194
    v_exp_f32 v195, v195
    v_exp_f32 v196, v196
    v_mfma_f32_32x32x16_bf16 v[208:223], v[188:191], v[180:183], v[240:255]
    ds_read_b128 v[184:187], v42 offset:34816
    v_exp_f32 v197, v197
    v_exp_f32 v198, v198
    v_exp_f32 v199, v199
    v_exp_f32 v200, v200
    v_exp_f32 v201, v201
    v_exp_f32 v202, v202
    v_smfmac_f32_32x32x32_bf16 v[144:159], v[136:139], v[192:199], v18
    v_exp_f32 v203, v203
    v_exp_f32 v204, v204
    v_exp_f32 v205, v205
    v_exp_f32 v206, v206
    v_exp_f32 v207, v207
    v_exp_f32 v208, v208
    v_exp_f32 v209, v209
    v_smfmac_f32_32x32x32_bf16 v[144:159], v[140:143], v[200:207], v18
    s_mov_b32 s22, 36864
    s_mov_b64 exec, s[32:33]
    buffer_load_dword v54, v40, s[52:55], s22 offen sc1
    s_mov_b64 exec, -1
    v_exp_f32 v210, v210
    v_exp_f32 v211, v211
    v_exp_f32 v212, v212
    s_waitcnt lgkmcnt(0)
    v_mfma_f32_32x32x16_bf16 v[192:207], v[184:187], v[176:179], v[224:239]
    v_exp_f32 v213, v213
    v_exp_f32 v214, v214
    v_exp_f32 v215, v215
    v_exp_f32 v216, v216
    v_exp_f32 v217, v217
    v_exp_f32 v218, v218
    v_smfmac_f32_32x32x32_bf16 v[160:175], v[136:139], v[208:215], v18
    v_exp_f32 v219, v219
    v_exp_f32 v220, v220
    v_exp_f32 v221, v221
    v_exp_f32 v222, v222
    v_exp_f32 v223, v223
    s_setprio 1
    v_exp_f32 v192, v192
    v_exp_f32 v193, v193
    v_smfmac_f32_32x32x32_bf16 v[160:175], v[140:143], v[216:223], v18
    s_mov_b64 exec, s[84:85]
    ds_read_b128 v[136:139], v43 offset:35840
    ds_read_b128 v[140:143], v43 offset:36352
    s_mov_b64 exec, -1
    v_exp_f32 v194, v194
    v_exp_f32 v195, v195
    v_exp_f32 v196, v196
    v_mfma_f32_32x32x16_bf16 v[208:223], v[184:187], v[180:183], v[240:255]
    ds_read_b128 v[188:191], v42 offset:35840
    v_exp_f32 v197, v197
    v_exp_f32 v198, v198
    v_exp_f32 v199, v199
    v_exp_f32 v200, v200
    v_exp_f32 v201, v201
    v_exp_f32 v202, v202
    v_smfmac_f32_32x32x32_bf16 v[144:159], v[128:131], v[192:199], v18
    v_exp_f32 v203, v203
    v_exp_f32 v204, v204
    v_exp_f32 v205, v205
    v_exp_f32 v206, v206
    v_exp_f32 v207, v207
    s_setprio 0
    v_exp_f32 v208, v208
    v_exp_f32 v209, v209
    v_smfmac_f32_32x32x32_bf16 v[144:159], v[132:135], v[200:207], v18
    v_exp_f32 v210, v210
    v_exp_f32 v211, v211
    v_exp_f32 v212, v212
    s_waitcnt lgkmcnt(0)
    v_mfma_f32_32x32x16_bf16 v[192:207], v[188:191], v[176:179], v[224:239]
    v_exp_f32 v213, v213
    v_exp_f32 v214, v214
    v_exp_f32 v215, v215
    v_exp_f32 v216, v216
    v_exp_f32 v217, v217
    v_exp_f32 v218, v218
    v_smfmac_f32_32x32x32_bf16 v[160:175], v[128:131], v[208:215], v18
    s_waitcnt vmcnt(0)
    v_cmp_ne_u32 vcc, v54, v2
    s_and_b32 s22, vcc_lo, s32
    s_cbranch_scc1 L_spin_18
L_back_19:
    v_exp_f32 v219, v219
    v_exp_f32 v220, v220
    v_exp_f32 v221, v221
    v_exp_f32 v222, v222
    v_exp_f32 v223, v223
    s_barrier
    s_setprio 3
    v_exp_f32 v192, v192
    v_exp_f32 v193, v193
    v_smfmac_f32_32x32x32_bf16 v[160:175], v[132:135], v[216:223], v18
    s_mov_b64 exec, s[84:85]
    ds_read_b128 v[128:131], v43 offset:49152
    ds_read_b128 v[132:135], v43 offset:49664
    s_mov_b64 exec, -1
    v_exp_f32 v194, v194
    v_exp_f32 v195, v195
    v_exp_f32 v196, v196
    v_mfma_f32_32x32x16_bf16 v[208:223], v[188:191], v[180:183], v[240:255]
    ds_read_b128 v[184:187], v42 offset:49152
    v_exp_f32 v197, v197
    v_exp_f32 v198, v198
    v_exp_f32 v199, v199
    v_exp_f32 v200, v200
    v_exp_f32 v201, v201
    v_exp_f32 v202, v202
    v_smfmac_f32_32x32x32_bf16 v[144:159], v[136:139], v[192:199], v18
    s_add_u32 m0, s80, 0
    s_xor_b32 s22, s16, 0
    buffer_load_dwordx4 v44, s[56:59], s22 offen  lds
    v_exp_f32 v203, v203
    v_exp_f32 v204, v204
    v_exp_f32 v205, v205
    v_exp_f32 v206, v206
    v_exp_f32 v207, v207
    v_exp_f32 v208, v208
    v_exp_f32 v209, v209
    v_smfmac_f32_32x32x32_bf16 v[144:159], v[140:143], v[200:207], v18
    s_add_u32 m0, s81, 98304
    s_mov_b32 s22, 2097152
    buffer_load_dwordx4 v45, s[52:55], s22 offen offset:0 sc1 lds
    v_exp_f32 v210, v210
    v_exp_f32 v211, v211
    v_exp_f32 v212, v212
    s_waitcnt lgkmcnt(0)
    v_mfma_f32_32x32x16_bf16 v[192:207], v[184:187], v[176:179], v[224:239]
    s_add_u32 m0, s80, 8192
    s_xor_b32 s22, s16, 65536
    buffer_load_dwordx4 v44, s[56:59], s22 offen  lds
    v_exp_f32 v213, v213
    v_exp_f32 v214, v214
    v_exp_f32 v215, v215
    v_exp_f32 v216, v216
    v_exp_f32 v217, v217
    v_exp_f32 v218, v218
    v_smfmac_f32_32x32x32_bf16 v[160:175], v[136:139], v[208:215], v18
    v_exp_f32 v219, v219
    v_exp_f32 v220, v220
    v_exp_f32 v221, v221
    v_exp_f32 v222, v222
    v_exp_f32 v223, v223
    v_exp_f32 v192, v192
    v_exp_f32 v193, v193
    v_smfmac_f32_32x32x32_bf16 v[160:175], v[140:143], v[216:223], v18
    s_mov_b64 exec, s[84:85]
    ds_read_b128 v[136:139], v43 offset:50176
    ds_read_b128 v[140:143], v43 offset:50688
    s_mov_b64 exec, -1
    v_exp_f32 v194, v194
    v_exp_f32 v195, v195
    v_exp_f32 v196, v196
    v_mfma_f32_32x32x16_bf16 v[208:223], v[184:187], v[180:183], v[240:255]
    ds_read_b128 v[188:191], v42 offset:50176
    v_exp_f32 v197, v197
    v_exp_f32 v198, v198
    v_exp_f32 v199, v199
    v_exp_f32 v200, v200
    v_exp_f32 v201, v201
    v_exp_f32 v202, v202
    v_smfmac_f32_32x32x32_bf16 v[144:159], v[128:131], v[192:199], v18
    s_add_u32 m0, s80, 16384
    s_xor_b32 s22, s16, 131072
    buffer_load_dwordx4 v44, s[56:59], s22 offen  lds
    v_exp_f32 v203, v203
    v_exp_f32 v204, v204
    v_exp_f32 v205, v205
    v_exp_f32 v206, v206
    v_exp_f32 v207, v207
    v_exp_f32 v208, v208
    v_exp_f32 v209, v209
    v_smfmac_f32_32x32x32_bf16 v[144:159], v[132:135], v[200:207], v18
    s_add_u32 m0, s81, 98304
    s_mov_b32 s22, 2097152
    buffer_load_dwordx4 v45, s[52:55], s22 offen offset:1024 sc1 lds
    v_exp_f32 v210, v210
    v_exp_f32 v211, v211
    v_exp_f32 v212, v212
    s_waitcnt lgkmcnt(0)
    v_mfma_f32_32x32x16_bf16 v[192:207], v[188:191], v[176:179], v[224:239]
    s_add_u32 m0, s80, 24576
    s_xor_b32 s22, s16, 196608
    buffer_load_dwordx4 v44, s[56:59], s22 offen  lds
    v_exp_f32 v213, v213
    v_exp_f32 v214, v214
    v_exp_f32 v215, v215
    v_exp_f32 v216, v216
    v_exp_f32 v217, v217
    v_exp_f32 v218, v218
    v_smfmac_f32_32x32x32_bf16 v[160:175], v[128:131], v[208:215], v18
    v_exp_f32 v219, v219
    v_exp_f32 v220, v220
    v_exp_f32 v221, v221
    v_exp_f32 v222, v222
    v_exp_f32 v223, v223
    s_setprio 2
    v_exp_f32 v192, v192
    v_exp_f32 v193, v193
    v_smfmac_f32_32x32x32_bf16 v[160:175], v[132:135], v[216:223], v18
    s_mov_b64 exec, s[84:85]
    ds_read_b128 v[128:131], v43 offset:51200
    ds_read_b128 v[132:135], v43 offset:51712
    s_mov_b64 exec, -1
    v_exp_f32 v194, v194
    v_exp_f32 v195, v195
    v_exp_f32 v196, v196
    v_mfma_f32_32x32x16_bf16 v[208:223], v[188:191], v[180:183], v[240:255]
    ds_read_b128 v[184:187], v42 offset:51200
    v_exp_f32 v197, v197
    v_exp_f32 v198, v198
    v_exp_f32 v199, v199
    v_exp_f32 v200, v200
    v_exp_f32 v201, v201
    v_exp_f32 v202, v202
    v_smfmac_f32_32x32x32_bf16 v[144:159], v[136:139], v[192:199], v18
    s_xor_b32 s22, s18, 0
    buffer_load_dwordx4 v[10:13], v19, s[52:55], s22 offen sc1
    v_exp_f32 v203, v203
    v_exp_f32 v204, v204
    v_exp_f32 v205, v205
    v_exp_f32 v206, v206
    v_exp_f32 v207, v207
    v_exp_f32 v208, v208
    v_exp_f32 v209, v209
    v_smfmac_f32_32x32x32_bf16 v[144:159], v[140:143], v[200:207], v18
    s_xor_b32 s22, s18, 4096
    buffer_load_dwordx4 v[14:17], v19, s[52:55], s22 offen sc1
    v_exp_f32 v210, v210
    v_exp_f32 v211, v211
    v_exp_f32 v212, v212
    s_waitcnt lgkmcnt(0)
    v_mfma_f32_32x32x16_bf16 v[192:207], v[184:187], v[176:179], v[224:239]
    v_exp_f32 v213, v213
    v_exp_f32 v214, v214
    v_exp_f32 v215, v215
    v_exp_f32 v216, v216
    v_exp_f32 v217, v217
    v_exp_f32 v218, v218
    v_smfmac_f32_32x32x32_bf16 v[160:175], v[136:139], v[208:215], v18
    s_xor_b32 s22, s18, 8192
    buffer_load_dwordx4 v[22:25], v19, s[52:55], s22 offen sc1
    v_exp_f32 v219, v219
    v_exp_f32 v220, v220
    v_exp_f32 v221, v221
    v_exp_f32 v222, v222
    v_exp_f32 v223, v223
    s_setprio 1
    v_exp_f32 v192, v192
    v_exp_f32 v193, v193
    v_smfmac_f32_32x32x32_bf16 v[160:175], v[140:143], v[216:223], v18
    s_mov_b64 exec, s[84:85]
    ds_read_b128 v[136:139], v43 offset:52224
    ds_read_b128 v[140:143], v43 offset:52736
    s_mov_b64 exec, -1
    v_exp_f32 v194, v194
    v_exp_f32 v195, v195
    v_exp_f32 v196, v196
    v_mfma_f32_32x32x16_bf16 v[208:223], v[184:187], v[180:183], v[240:255]
    ds_read_b128 v[188:191], v42 offset:52224
    v_exp_f32 v197, v197
    v_exp_f32 v198, v198
    v_exp_f32 v199, v199
    v_exp_f32 v200, v200
    v_exp_f32 v201, v201
    v_exp_f32 v202, v202
    v_smfmac_f32_32x32x32_bf16 v[144:159], v[128:131], v[192:199], v18
    s_xor_b32 s22, s18, 12288
    buffer_load_dwordx4 v[26:29], v19, s[52:55], s22 offen sc1
    v_exp_f32 v203, v203
    v_exp_f32 v204, v204
    v_exp_f32 v205, v205
    v_exp_f32 v206, v206
    v_exp_f32 v207, v207
    s_setprio 0
    v_exp_f32 v208, v208
    v_exp_f32 v209, v209
    v_smfmac_f32_32x32x32_bf16 v[144:159], v[132:135], v[200:207], v18
    v_exp_f32 v210, v210
    v_exp_f32 v211, v211
    v_exp_f32 v212, v212
    s_waitcnt lgkmcnt(0)
    v_mfma_f32_32x32x16_bf16 v[192:207], v[188:191], v[176:179], v[224:239]
    s_xor_b32 s22, s18, 24576
    buffer_load_dwordx4 v[48:51], v19, s[52:55], s22 offen sc1
    v_exp_f32 v213, v213
    v_exp_f32 v214, v214
    v_exp_f32 v215, v215
    v_exp_f32 v216, v216
    v_exp_f32 v217, v217
    v_exp_f32 v218, v218
    v_smfmac_f32_32x32x32_bf16 v[160:175], v[128:131], v[208:215], v18
    v_exp_f32 v219, v219
    v_exp_f32 v220, v220
    v_exp_f32 v221, v221
    v_exp_f32 v222, v222
    v_exp_f32 v223, v223
    s_waitcnt vmcnt(5)
    s_barrier
    s_setprio 3
    v_exp_f32 v192, v192
    v_exp_f32 v193, v193
    v_smfmac_f32_32x32x32_bf16 v[160:175], v[132:135], v[216:223], v18
    s_mov_b64 exec, s[84:85]
    ds_read_b128 v[128:131], v43 offset:0
    ds_read_b128 v[132:135], v43 offset:512
    s_mov_b64 exec, -1
    v_exp_f32 v194, v194
    v_exp_f32 v195, v195
    v_exp_f32 v196, v196
    v_mfma_f32_32x32x16_bf16 v[208:223], v[188:191], v[180:183], v[240:255]
    ds_read_b128 v[184:187], v42 offset:0
    v_exp_f32 v197, v197
    ds_read_b64_tr_b16 v[96:97], v52 offset:0
    ds_read_b64_tr_b16 v[98:99], v52 offset:1024
    v_exp_f32 v198, v198
    ds_read_b64_tr_b16 v[100:101], v53 offset:0
    ds_read_b64_tr_b16 v[102:103], v53 offset:1024
    v_exp_f32 v199, v199
    v_exp_f32 v200, v200
    v_exp_f32 v201, v201
    v_exp_f32 v202, v202
    v_smfmac_f32_32x32x32_bf16 v[144:159], v[136:139], v[192:199], v18
    s_add_u32 m0, s80, 32768
    s_xor_b32 s22, s16, 262144
    buffer_load_dwordx4 v44, s[56:59], s22 offen  lds
    v_exp_f32 v203, v203
    v_exp_f32 v204, v204
    v_exp_f32 v205, v205
    v_exp_f32 v206, v206
    v_exp_f32 v207, v207
    v_exp_f32 v208, v208
    v_exp_f32 v209, v209
    v_smfmac_f32_32x32x32_bf16 v[144:159], v[140:143], v[200:207], v18
    s_add_u32 m0, s81, 114688
    s_mov_b32 s22, 2621440
    buffer_load_dwordx4 v45, s[52:55], s22 offen offset:0 sc1 lds
    v_exp_f32 v210, v210
    v_exp_f32 v211, v211
    v_exp_f32 v212, v212
    s_waitcnt vmcnt(6) lgkmcnt(0)
    v_mfma_f32_32x32x16_bf16 v[192:207], v[184:187], v[176:179], v[224:239]
    s_add_u32 m0, s80, 40960
    s_xor_b32 s22, s16, 327680
    buffer_load_dwordx4 v44, s[56:59], s22 offen  lds
    v_exp_f32 v213, v213
    v_exp_f32 v214, v214
    v_exp_f32 v215, v215
    v_exp_f32 v216, v216
    v_exp_f32 v217, v217
    v_exp_f32 v218, v218
    v_smfmac_f32_32x32x32_bf16 v[160:175], v[136:139], v[208:215], v18
    v_exp_f32 v219, v219
    v_exp_f32 v220, v220
    v_exp_f32 v221, v221
    v_mfma_f32_32x32x16_bf16 v[64:79], v[10:13], v[96:99], 0
    v_exp_f32 v222, v222
    v_exp_f32 v223, v223
    v_exp_f32 v192, v192
    v_exp_f32 v193, v193
L_page4:
    s_cbranch_execz L_it2
    v_smfmac_f32_32x32x32_bf16 v[160:175], v[140:143], v[216:223], v18
    s_mov_b64 exec, s[84:85]
    ds_read_b128 v[136:139], v43 offset:1024
    ds_read_b128 v[140:143], v43 offset:1536
    s_mov_b64 exec, -1
    v_exp_f32 v194, v194
    v_exp_f32 v195, v195
    v_exp_f32 v196, v196
    v_mfma_f32_32x32x16_bf16 v[208:223], v[184:187], v[180:183], v[240:255]
    ds_read_b128 v[188:191], v42 offset:1024
    v_exp_f32 v197, v197
    ds_read_b64_tr_b16 v[104:105], v52 offset:8192
    ds_read_b64_tr_b16 v[106:107], v52 offset:9216
    v_exp_f32 v198, v198
    ds_read_b64_tr_b16 v[108:109], v53 offset:8192
    ds_read_b64_tr_b16 v[110:111], v53 offset:9216
    v_exp_f32 v199, v199
    v_exp_f32 v200, v200
    v_exp_f32 v201, v201
    v_exp_f32 v202, v202
    v_smfmac_f32_32x32x32_bf16 v[144:159], v[128:131], v[192:199], v18
    s_add_u32 m0, s80, 81920
    s_mov_b32 s22, 1310720
    buffer_load_dwordx4 v44, s[56:59], s22 offen  lds
    v_exp_f32 v203, v203
    v_exp_f32 v204, v204
    v_exp_f32 v205, v205
    v_mfma_f32_32x32x16_bf16 v[80:95], v[10:13], v[100:103], 0
    v_exp_f32 v206, v206
    v_exp_f32 v207, v207
    v_exp_f32 v208, v208
    v_exp_f32 v209, v209
    v_smfmac_f32_32x32x32_bf16 v[144:159], v[132:135], v[200:207], v18
    s_add_u32 m0, s81, 114688
    s_mov_b32 s22, 2621440
    buffer_load_dwordx4 v45, s[52:55], s22 offen offset:1024 sc1 lds
    v_exp_f32 v210, v210
    v_exp_f32 v211, v211
    v_exp_f32 v212, v212
    s_waitcnt vmcnt(8) lgkmcnt(0)
    v_mfma_f32_32x32x16_bf16 v[192:207], v[188:191], v[176:179], v[224:239]
    s_add_u32 m0, s80, 90112
    s_mov_b32 s22, 1376256
    buffer_load_dwordx4 v44, s[56:59], s22 offen  lds
    v_exp_f32 v213, v213
    v_exp_f32 v214, v214
    v_exp_f32 v215, v215
    v_exp_f32 v216, v216
    v_exp_f32 v217, v217
    v_exp_f32 v218, v218
    v_smfmac_f32_32x32x32_bf16 v[160:175], v[128:131], v[208:215], v18
    v_exp_f32 v219, v219
    v_exp_f32 v220, v220
    v_exp_f32 v221, v221
    v_mfma_f32_32x32x16_bf16 v[64:79], v[14:17], v[104:107], v[64:79]
    v_exp_f32 v222, v222
    v_exp_f32 v223, v223
    s_setprio 2
    v_exp_f32 v192, v192
    v_exp_f32 v193, v193
    v_smfmac_f32_32x32x32_bf16 v[160:175], v[132:135], v[216:223], v18
    s_mov_b64 exec, s[84:85]
    ds_read_b128 v[128:131], v43 offset:2048
    ds_read_b128 v[132:135], v43 offset:2560
    s_mov_b64 exec, -1
    v_exp_f32 v194, v194
    v_exp_f32 v195, v195
    v_exp_f32 v196, v196
    v_mfma_f32_32x32x16_bf16 v[208:223], v[188:191], v[180:183], v[240:255]
    ds_read_b128 v[184:187], v42 offset:2048
    v_exp_f32 v197, v197
    ds_read_b64_tr_b16 v[96:97], v52 offset:16384
    ds_read_b64_tr_b16 v[98:99], v52 offset:17408
    v_exp_f32 v198, v198
    ds_read_b64_tr_b16 v[100:101], v53 offset:16384
    ds_read_b64_tr_b16 v[102:103], v53 offset:17408
    v_exp_f32 v199, v199
    v_exp_f32 v200, v200
    v_exp_f32 v201, v201
    v_exp_f32 v202, v202
    v_smfmac_f32_32x32x32_bf16 v[144:159], v[136:139], v[192:199], v18
    s_xor_b32 s22, s18, 16384
    buffer_load_dwordx4 v[30:33], v19, s[52:55], s22 offen sc1
    v_exp_f32 v203, v203
    v_exp_f32 v204, v204
    v_exp_f32 v205, v205
    v_mfma_f32_32x32x16_bf16 v[80:95], v[14:17], v[108:111], v[80:95]
    v_exp_f32 v206, v206
    v_exp_f32 v207, v207
    v_exp_f32 v208, v208
    v_exp_f32 v209, v209
    v_smfmac_f32_32x32x32_bf16 v[144:159], v[140:143], v[200:207], v18
    s_xor_b32 s22, s18, 20480
    buffer_load_dwordx4 v[34:37], v19, s[52:55], s22 offen sc1
    v_exp_f32 v210, v210
    v_exp_f32 v211, v211
    v_exp_f32 v212, v212
    s_waitcnt vmcnt(10) lgkmcnt(0)
    v_mfma_f32_32x32x16_bf16 v[192:207], v[184:187], v[176:179], v[224:239]
    v_exp_f32 v213, v213
    v_exp_f32 v214, v214
    v_exp_f32 v215, v215
    v_exp_f32 v216, v216
    v_exp_f32 v217, v217
    v_exp_f32 v218, v218
    v_smfmac_f32_32x32x32_bf16 v[160:175], v[136:139], v[208:215], v18
    s_xor_b32 s22, s18, 28672
    buffer_load_dwordx4 v[60:63], v19, s[52:55], s22 offen sc1
    v_exp_f32 v219, v219
    v_exp_f32 v220, v220
    v_exp_f32 v221, v221
    v_mfma_f32_32x32x16_bf16 v[64:79], v[22:25], v[96:99], v[64:79]
    v_exp_f32 v222, v222
    v_exp_f32 v223, v223
    s_setprio 1
    v_exp_f32 v192, v192
    v_exp_f32 v193, v193
    v_smfmac_f32_32x32x32_bf16 v[160:175], v[140:143], v[216:223], v18
    s_mov_b64 exec, s[84:85]
    ds_read_b128 v[136:139], v43 offset:3072
    ds_read_b128 v[140:143], v43 offset:3584
    s_mov_b64 exec, -1
    v_exp_f32 v194, v194
    v_exp_f32 v195, v195
    v_exp_f32 v196, v196
    v_mfma_f32_32x32x16_bf16 v[208:223], v[184:187], v[180:183], v[240:255]
    ds_read_b128 v[188:191], v42 offset:3072
    v_exp_f32 v197, v197
    ds_read_b64_tr_b16 v[104:105], v52 offset:24576
    ds_read_b64_tr_b16 v[106:107], v52 offset:25600
    v_exp_f32 v198, v198
    ds_read_b64_tr_b16 v[108:109], v53 offset:24576
    ds_read_b64_tr_b16 v[110:111], v53 offset:25600
    v_exp_f32 v199, v199
    v_exp_f32 v200, v200
    v_exp_f32 v201, v201
    v_exp_f32 v202, v202
    v_smfmac_f32_32x32x32_bf16 v[144:159], v[128:131], v[192:199], v18
    s_xor_b32 s22, s18, 32768
    buffer_load_dwordx4 v[112:115], v19, s[52:55], s22 offen sc1
    v_exp_f32 v203, v203
    v_exp_f32 v204, v204
    v_exp_f32 v205, v205
    v_mfma_f32_32x32x16_bf16 v[80:95], v[22:25], v[100:103], v[80:95]
    v_exp_f32 v206, v206
    v_exp_f32 v207, v207
    s_setprio 0
    v_exp_f32 v208, v208
    v_exp_f32 v209, v209
    v_smfmac_f32_32x32x32_bf16 v[144:159], v[132:135], v[200:207], v18
    v_exp_f32 v210, v210
    v_exp_f32 v211, v211
    v_exp_f32 v212, v212
    s_waitcnt vmcnt(11) lgkmcnt(0)
    v_mfma_f32_32x32x16_bf16 v[192:207], v[188:191], v[176:179], v[224:239]
    s_xor_b32 s22, s18, 36864
    buffer_load_dwordx4 v[116:119], v19, s[52:55], s22 offen sc1
    v_exp_f32 v213, v213
    v_exp_f32 v214, v214
    v_exp_f32 v215, v215
    v_exp_f32 v216, v216
    v_exp_f32 v217, v217
    v_exp_f32 v218, v218
    v_smfmac_f32_32x32x32_bf16 v[160:175], v[128:131], v[208:215], v18
    v_exp_f32 v219, v219
    v_exp_f32 v220, v220
    v_exp_f32 v221, v221
    v_mfma_f32_32x32x16_bf16 v[64:79], v[26:29], v[104:107], v[64:79]
    v_exp_f32 v222, v222
    v_exp_f32 v223, v223
    s_waitcnt vmcnt(6)
    s_barrier
    s_setprio 3
    v_exp_f32 v192, v192
    v_exp_f32 v193, v193
    v_smfmac_f32_32x32x32_bf16 v[160:175], v[132:135], v[216:223], v18
    s_mov_b64 exec, s[84:85]
    ds_read_b128 v[128:131], v43 offset:16384
    ds_read_b128 v[132:135], v43 offset:16896
    s_mov_b64 exec, -1
    v_exp_f32 v194, v194
    v_exp_f32 v195, v195
    v_exp_f32 v196, v196
    v_mfma_f32_32x32x16_bf16 v[208:223], v[188:191], v[180:183], v[240:255]
    ds_read_b128 v[184:187], v42 offset:16384
    v_exp_f32 v197, v197
    ds_read_b64_tr_b16 v[96:97], v52 offset:32768
    ds_read_b64_tr_b16 v[98:99], v52 offset:33792
    v_exp_f32 v198, v198
    ds_read_b64_tr_b16 v[100:101], v53 offset:32768
    ds_read_b64_tr_b16 v[102:103], v53 offset:33792
    v_exp_f32 v199, v199
    v_exp_f32 v200, v200
    v_exp_f32 v201, v201
    v_exp_f32 v202, v202
    v_smfmac_f32_32x32x32_bf16 v[144:159], v[136:139], v[192:199], v18
    s_add_u32 m0, s80, 98304
    s_xor_b32 s22, s16, 393216
    buffer_load_dwordx4 v44, s[56:59], s22 offen  lds
    v_exp_f32 v203, v203
    v_exp_f32 v204, v204
    v_exp_f32 v205, v205
    v_mfma_f32_32x32x16_bf16 v[80:95], v[26:29], v[108:111], v[80:95]
    v_exp_f32 v206, v206
    v_exp_f32 v207, v207
    v_exp_f32 v208, v208
    v_exp_f32 v209, v209
    v_smfmac_f32_32x32x32_bf16 v[144:159], v[140:143], v[200:207], v18
    s_add_u32 m0, s81, 131072
    s_mov_b32 s22, 3145728
    buffer_load_dwordx4 v45, s[52:55], s22 offen offset:0 sc1 lds
    v_exp_f32 v210, v210
    v_exp_f32 v211, v211
    v_exp_f32 v212, v212
    s_waitcnt vmcnt(6) lgkmcnt(0)
    v_mfma_f32_32x32x16_bf16 v[192:207], v[184:187], v[176:179], v[224:239]
    s_add_u32 m0, s80, 106496
    s_xor_b32 s22, s16, 458752
    buffer_load_dwordx4 v44, s[56:59], s22 offen  lds
    v_exp_f32 v213, v213
    v_exp_f32 v214, v214
    v_exp_f32 v215, v215
    v_exp_f32 v216, v216
    v_exp_f32 v217, v217
    v_exp_f32 v218, v218
    v_smfmac_f32_32x32x32_bf16 v[160:175], v[136:139], v[208:215], v18
    v_exp_f32 v219, v219
    v_exp_f32 v220, v220
    v_exp_f32 v221, v221
    v_mfma_f32_32x32x16_bf16 v[64:79], v[30:33], v[96:99], v[64:79]
    v_exp_f32 v222, v222
    v_exp_f32 v223, v223
    v_exp_f32 v192, v192
    v_exp_f32 v193, v193
    v_smfmac_f32_32x32x32_bf16 v[160:175], v[140:143], v[216:223], v18
    s_mov_b64 exec, s[84:85]
    ds_read_b128 v[136:139], v43 offset:17408
    ds_read_b128 v[140:143], v43 offset:17920
    s_mov_b64 exec, -1
    v_exp_f32 v194, v194
    v_exp_f32 v195, v195
    v_exp_f32 v196, v196
    v_mfma_f32_32x32x16_bf16 v[208:223], v[184:187], v[180:183], v[240:255]
    ds_read_b128 v[188:191], v42 offset:17408
    v_exp_f32 v197, v197
    ds_read_b64_tr_b16 v[104:105], v52 offset:40960
    ds_read_b64_tr_b16 v[106:107], v52 offset:41984
    v_exp_f32 v198, v198
    ds_read_b64_tr_b16 v[108:109], v53 offset:40960
    ds_read_b64_tr_b16 v[110:111], v53 offset:41984
    v_exp_f32 v199, v199
    v_exp_f32 v200, v200
    v_exp_f32 v201, v201
    v_exp_f32 v202, v202
    v_smfmac_f32_32x32x32_bf16 v[144:159], v[128:131], v[192:199], v18
    s_add_u32 m0, s80, 0
    s_xor_b32 s22, s16, 655360
    buffer_load_dwordx4 v44, s[56:59], s22 offen  lds
    v_exp_f32 v203, v203
    v_exp_f32 v204, v204
    v_exp_f32 v205, v205
    v_mfma_f32_32x32x16_bf16 v[80:95], v[30:33], v[100:103], v[80:95]
    v_exp_f32 v206, v206
    v_exp_f32 v207, v207
    v_exp_f32 v208, v208
    v_exp_f32 v209, v209
    v_smfmac_f32_32x32x32_bf16 v[144:159], v[132:135], v[200:207], v18
    s_add_u32 m0, s81, 131072
    s_mov_b32 s22, 3145728
    buffer_load_dwordx4 v45, s[52:55], s22 offen offset:1024 sc1 lds
    v_exp_f32 v210, v210
    v_exp_f32 v211, v211
    v_exp_f32 v212, v212
    s_waitcnt vmcnt(8) lgkmcnt(0)
    v_mfma_f32_32x32x16_bf16 v[192:207], v[188:191], v[176:179], v[224:239]
    s_add_u32 m0, s80, 8192
    s_xor_b32 s22, s16, 720896
    buffer_load_dwordx4 v44, s[56:59], s22 offen  lds
    v_exp_f32 v213, v213
    v_exp_f32 v214, v214
    v_exp_f32 v215, v215
    v_exp_f32 v216, v216
    v_exp_f32 v217, v217
    v_exp_f32 v218, v218
    v_smfmac_f32_32x32x32_bf16 v[160:175], v[128:131], v[208:215], v18
    v_exp_f32 v219, v219
    v_exp_f32 v220, v220
    v_exp_f32 v221, v221
    v_mfma_f32_32x32x16_bf16 v[64:79], v[34:37], v[104:107], v[64:79]
    v_exp_f32 v222, v222
    v_exp_f32 v223, v223
    s_setprio 2
    v_exp_f32 v192, v192
    v_exp_f32 v193, v193
    v_smfmac_f32_32x32x32_bf16 v[160:175], v[132:135], v[216:223], v18
    s_mov_b64 exec, s[84:85]
    ds_read_b128 v[128:131], v43 offset:18432
    ds_read_b128 v[132:135], v43 offset:18944
    s_mov_b64 exec, -1
    v_exp_f32 v194, v194
    v_exp_f32 v195, v195
    v_exp_f32 v196, v196
    v_mfma_f32_32x32x16_bf16 v[208:223], v[188:191], v[180:183], v[240:255]
    ds_read_b128 v[184:187], v42 offset:18432
    v_exp_f32 v197, v197
    v_exp_f32 v198, v198
    v_exp_f32 v199, v199
    v_exp_f32 v200, v200
    v_exp_f32 v201, v201
    v_exp_f32 v202, v202
    v_smfmac_f32_32x32x32_bf16 v[144:159], v[136:139], v[192:199], v18
    s_xor_b32 s22, s18, 40960
    buffer_load_dwordx4 v[120:123], v19, s[52:55], s22 offen sc1
    v_exp_f32 v203, v203
    v_exp_f32 v204, v204
    v_exp_f32 v205, v205
    v_mfma_f32_32x32x16_bf16 v[80:95], v[34:37], v[108:111], v[80:95]
    v_exp_f32 v206, v206
    v_exp_f32 v207, v207
    v_exp_f32 v208, v208
    v_exp_f32 v209, v209
    v_smfmac_f32_32x32x32_bf16 v[144:159], v[140:143], v[200:207], v18
    s_xor_b32 s22, s18, 45056
    buffer_load_dwordx4 v[124:127], v19, s[52:55], s22 offen sc1
    v_exp_f32 v210, v210
    v_exp_f32 v211, v211
    v_exp_f32 v212, v212
    s_waitcnt lgkmcnt(0)
    v_mfma_f32_32x32x16_bf16 v[192:207], v[184:187], v[176:179], v[224:239]
    v_exp_f32 v213, v213
    v_exp_f32 v214, v214
    v_exp_f32 v215, v215
    v_exp_f32 v216, v216
    v_exp_f32 v217, v217
    v_exp_f32 v218, v218
    v_smfmac_f32_32x32x32_bf16 v[160:175], v[136:139], v[208:215], v18
    s_xor_b32 s22, s18, 49152
    buffer_load_dwordx4 v[10:13], v19, s[52:55], s22 offen sc1
    v_exp_f32 v219, v219
    v_exp_f32 v220, v220
    v_exp_f32 v221, v221
    v_exp_f32 v222, v222
    v_exp_f32 v223, v223
    s_setprio 1
    v_exp_f32 v192, v192
    v_exp_f32 v193, v193
    v_smfmac_f32_32x32x32_bf16 v[160:175], v[140:143], v[216:223], v18
    s_mov_b64 exec, s[84:85]
    ds_read_b128 v[136:139], v43 offset:19456
    ds_read_b128 v[140:143], v43 offset:19968
    s_mov_b64 exec, -1
    v_exp_f32 v194, v194
    v_exp_f32 v195, v195
    v_exp_f32 v196, v196
    v_mfma_f32_32x32x16_bf16 v[208:223], v[184:187], v[180:183], v[240:255]
    ds_read_b128 v[188:191], v42 offset:19456
    v_exp_f32 v197, v197
    v_exp_f32 v198, v198
    v_exp_f32 v199, v199
    v_exp_f32 v200, v200
    v_exp_f32 v201, v201
    v_exp_f32 v202, v202
    v_smfmac_f32_32x32x32_bf16 v[144:159], v[128:131], v[192:199], v18
    s_xor_b32 s22, s18, 53248
    buffer_load_dwordx4 v[14:17], v19, s[52:55], s22 offen sc1
    v_exp_f32 v203, v203
    v_exp_f32 v204, v204
    v_exp_f32 v205, v205
    v_exp_f32 v206, v206
    v_exp_f32 v207, v207
    s_setprio 0
    v_exp_f32 v208, v208
    v_exp_f32 v209, v209
    v_smfmac_f32_32x32x32_bf16 v[144:159], v[132:135], v[200:207], v18
    v_exp_f32 v210, v210
    v_exp_f32 v211, v211
    v_exp_f32 v212, v212
    s_waitcnt lgkmcnt(0)
    v_mfma_f32_32x32x16_bf16 v[192:207], v[188:191], v[176:179], v[224:239]
    s_xor_b32 s22, s18, 57344
    buffer_load_dwordx4 v[22:25], v19, s[52:55], s22 offen sc1
    v_exp_f32 v213, v213
    v_exp_f32 v214, v214
    v_exp_f32 v215, v215
    v_exp_f32 v216, v216
    v_exp_f32 v217, v217
    v_exp_f32 v218, v218
    v_smfmac_f32_32x32x32_bf16 v[160:175], v[128:131], v[208:215], v18
    v_exp_f32 v219, v219
    v_exp_f32 v220, v220
    v_exp_f32 v221, v221
    v_exp_f32 v222, v222
    v_exp_f32 v223, v223
    s_waitcnt vmcnt(6)
    s_barrier
    s_setprio 3
    v_exp_f32 v192, v192
    v_exp_f32 v193, v193
    v_smfmac_f32_32x32x32_bf16 v[160:175], v[132:135], v[216:223], v18
    s_mov_b64 exec, s[84:85]
    ds_read_b128 v[128:131], v43 offset:32768
    ds_read_b128 v[132:135], v43 offset:33280
    s_mov_b64 exec, -1
    v_exp_f32 v194, v194
    v_exp_f32 v195, v195
    v_exp_f32 v196, v196
    v_mfma_f32_32x32x16_bf16 v[208:223], v[188:191], v[180:183], v[240:255]
    ds_read_b128 v[184:187], v42 offset:32768
    v_exp_f32 v197, v197
    v_exp_f32 v198, v198
    v_exp_f32 v199, v199
    v_exp_f32 v200, v200
    v_exp_f32 v201, v201
    v_exp_f32 v202, v202
    v_smfmac_f32_32x32x32_bf16 v[144:159], v[136:139], v[192:199], v18
    s_add_u32 m0, s80, 114688
    s_xor_b32 s22, s16, 524288
    buffer_load_dwordx4 v44, s[56:59], s22 offen  lds
    v_exp_f32 v203, v203
    v_exp_f32 v204, v204
    v_exp_f32 v205, v205
    v_exp_f32 v206, v206
    v_exp_f32 v207, v207
    v_exp_f32 v208, v208
    v_exp_f32 v209, v209
    v_smfmac_f32_32x32x32_bf16 v[144:159], v[140:143], v[200:207], v18
    s_add_u32 m0, s81, 147456
    s_mov_b32 s22, 3670016
    buffer_load_dwordx4 v45, s[52:55], s22 offen offset:0 sc1 lds
    v_exp_f32 v210, v210
    v_exp_f32 v211, v211
    v_exp_f32 v212, v212
    s_waitcnt lgkmcnt(0)
    v_mfma_f32_32x32x16_bf16 v[192:207], v[184:187], v[176:179], v[224:239]
    s_add_u32 m0, s80, 122880
    s_xor_b32 s22, s16, 589824
    buffer_load_dwordx4 v44, s[56:59], s22 offen  lds
    v_exp_f32 v213, v213
    v_exp_f32 v214, v214
    v_exp_f32 v215, v215
    v_exp_f32 v216, v216
    v_exp_f32 v217, v217
    v_exp_f32 v218, v218
    v_smfmac_f32_32x32x32_bf16 v[160:175], v[136:139], v[208:215], v18
    v_exp_f32 v219, v219
    v_exp_f32 v220, v220
    v_exp_f32 v221, v221
    v_exp_f32 v222, v222
    v_exp_f32 v223, v223
    v_exp_f32 v192, v192
    v_exp_f32 v193, v193
    v_smfmac_f32_32x32x32_bf16 v[160:175], v[140:143], v[216:223], v18
    s_mov_b64 exec, s[84:85]
    ds_read_b128 v[136:139], v43 offset:33792
    ds_read_b128 v[140:143], v43 offset:34304
    s_mov_b64 exec, -1
    v_exp_f32 v194, v194
    v_exp_f32 v195, v195
    v_exp_f32 v196, v196
    v_mfma_f32_32x32x16_bf16 v[208:223], v[184:187], v[180:183], v[240:255]
    ds_read_b128 v[188:191], v42 offset:33792
    v_exp_f32 v197, v197
    v_exp_f32 v198, v198
    v_exp_f32 v199, v199
    v_exp_f32 v200, v200
    v_exp_f32 v201, v201
    v_exp_f32 v202, v202
    v_smfmac_f32_32x32x32_bf16 v[144:159], v[128:131], v[192:199], v18
    s_add_u32 m0, s80, 16384
    s_xor_b32 s22, s16, 786432
    buffer_load_dwordx4 v44, s[56:59], s22 offen  lds
    v_exp_f32 v203, v203
    v_exp_f32 v204, v204
    v_exp_f32 v205, v205
    v_exp_f32 v206, v206
    v_exp_f32 v207, v207
    v_exp_f32 v208, v208
    v_exp_f32 v209, v209
    v_smfmac_f32_32x32x32_bf16 v[144:159], v[132:135], v[200:207], v18
    s_add_u32 m0, s81, 147456
    s_mov_b32 s22, 3670016
    buffer_load_dwordx4 v45, s[52:55], s22 offen offset:1024 sc1 lds
    v_exp_f32 v210, v210
    v_exp_f32 v211, v211
    v_exp_f32 v212, v212
    s_waitcnt lgkmcnt(0)
    v_mfma_f32_32x32x16_bf16 v[192:207], v[188:191], v[176:179], v[224:239]
    s_add_u32 m0, s80, 24576
    s_xor_b32 s22, s16, 851968
    buffer_load_dwordx4 v44, s[56:59], s22 offen  lds
    v_exp_f32 v213, v213
    v_exp_f32 v214, v214
    v_exp_f32 v215, v215
    v_exp_f32 v216, v216
    v_exp_f32 v217, v217
    v_exp_f32 v218, v218
    v_smfmac_f32_32x32x32_bf16 v[160:175], v[128:131], v[208:215], v18
    v_exp_f32 v219, v219
    v_exp_f32 v220, v220
    v_exp_f32 v221, v221
    v_exp_f32 v222, v222
    v_exp_f32 v223, v223
    s_setprio 2
    v_exp_f32 v192, v192
    v_exp_f32 v193, v193
    v_smfmac_f32_32x32x32_bf16 v[160:175], v[132:135], v[216:223], v18
    s_mov_b64 exec, s[84:85]
    ds_read_b128 v[128:131], v43 offset:34816
    ds_read_b128 v[132:135], v43 offset:35328
    s_mov_b64 exec, -1
    v_exp_f32 v194, v194
    v_exp_f32 v195, v195
    v_exp_f32 v196, v196
    v_mfma_f32_32x32x16_bf16 v[208:223], v[188:191], v[180:183], v[240:255]
    ds_read_b128 v[184:187], v42 offset:34816
    v_exp_f32 v197, v197
    v_exp_f32 v198, v198
    v_exp_f32 v199, v199
    v_exp_f32 v200, v200
    v_exp_f32 v201, v201
    v_exp_f32 v202, v202
    v_smfmac_f32_32x32x32_bf16 v[144:159], v[136:139], v[192:199], v18
    s_xor_b32 s22, s18, 61440
    buffer_load_dwordx4 v[26:29], v19, s[52:55], s22 offen sc1
    v_exp_f32 v203, v203
    v_exp_f32 v204, v204
    v_exp_f32 v205, v205
    v_exp_f32 v206, v206
    v_exp_f32 v207, v207
    v_exp_f32 v208, v208
    v_exp_f32 v209, v209
    v_smfmac_f32_32x32x32_bf16 v[144:159], v[140:143], v[200:207], v18
    s_xor_b32 s22, s21, 65536
    buffer_load_dwordx4 v[30:33], v19, s[52:55], s22 offen sc1
    v_exp_f32 v210, v210
    v_exp_f32 v211, v211
    v_exp_f32 v212, v212
    s_waitcnt lgkmcnt(0)
    v_mfma_f32_32x32x16_bf16 v[192:207], v[184:187], v[176:179], v[224:239]
    v_exp_f32 v213, v213
    v_exp_f32 v214, v214
    v_exp_f32 v215, v215
    v_exp_f32 v216, v216
    v_exp_f32 v217, v217
    v_exp_f32 v218, v218
    v_smfmac_f32_32x32x32_bf16 v[160:175], v[136:139], v[208:215], v18
    s_xor_b32 s22, s21, 69632
    buffer_load_dwordx4 v[34:37], v19, s[52:55], s22 offen sc1
    v_exp_f32 v219, v219
    v_exp_f32 v220, v220
    v_exp_f32 v221, v221
    v_exp_f32 v222, v222
    v_exp_f32 v223, v223
    s_setprio 1
    v_exp_f32 v192, v192
    v_exp_f32 v193, v193
    v_smfmac_f32_32x32x32_bf16 v[160:175], v[140:143], v[216:223], v18
    s_mov_b64 exec, s[84:85]
    ds_read_b128 v[136:139], v43 offset:35840
    ds_read_b128 v[140:143], v43 offset:36352
    s_mov_b64 exec, -1
    v_exp_f32 v194, v194
    v_exp_f32 v195, v195
    v_exp_f32 v196, v196
    v_mfma_f32_32x32x16_bf16 v[208:223], v[184:187], v[180:183], v[240:255]
    ds_read_b128 v[188:191], v42 offset:35840
    v_exp_f32 v197, v197
    v_exp_f32 v198, v198
    v_exp_f32 v199, v199
    v_exp_f32 v200, v200
    v_exp_f32 v201, v201
    v_exp_f32 v202, v202
    v_smfmac_f32_32x32x32_bf16 v[144:159], v[128:131], v[192:199], v18
    s_xor_b32 s22, s21, 73728
    buffer_load_dwordx4 v[96:99], v19, s[52:55], s22 offen sc1
    v_exp_f32 v203, v203
    v_exp_f32 v204, v204
    v_exp_f32 v205, v205
    v_exp_f32 v206, v206
    v_exp_f32 v207, v207
    s_setprio 0
    v_exp_f32 v208, v208
    v_exp_f32 v209, v209
    v_smfmac_f32_32x32x32_bf16 v[144:159], v[132:135], v[200:207], v18
    v_exp_f32 v210, v210
    v_exp_f32 v211, v211
    v_exp_f32 v212, v212
    s_waitcnt lgkmcnt(0)
    v_mfma_f32_32x32x16_bf16 v[192:207], v[188:191], v[176:179], v[224:239]
    s_xor_b32 s22, s21, 77824
    buffer_load_dwordx4 v[100:103], v19, s[52:55], s22 offen sc1
    v_exp_f32 v213, v213
    v_exp_f32 v214, v214
    v_exp_f32 v215, v215
    v_exp_f32 v216, v216
    v_exp_f32 v217, v217
    v_exp_f32 v218, v218
    v_smfmac_f32_32x32x32_bf16 v[160:175], v[128:131], v[208:215], v18
    v_exp_f32 v219, v219
    v_exp_f32 v220, v220
    v_exp_f32 v221, v221
    v_exp_f32 v222, v222
    v_exp_f32 v223, v223
    s_waitcnt vmcnt(6)
    s_barrier
    s_setprio 3
    v_exp_f32 v192, v192
    v_exp_f32 v193, v193
    v_smfmac_f32_32x32x32_bf16 v[160:175], v[132:135], v[216:223], v18
    s_mov_b64 exec, s[84:85]
    ds_read_b128 v[128:131], v43 offset:49152
    ds_read_b128 v[132:135], v43 offset:49664
    s_mov_b64 exec, -1
    v_exp_f32 v194, v194
    v_exp_f32 v195, v195
    v_exp_f32 v196, v196
    v_mfma_f32_32x32x16_bf16 v[208:223], v[188:191], v[180:183], v[240:255]
    ds_read_b128 v[184:187], v42 offset:49152
    v_exp_f32 v197, v197
    v_exp_f32 v198, v198
    v_exp_f32 v199, v199
    v_exp_f32 v200, v200
    v_exp_f32 v201, v201
    v_exp_f32 v202, v202
    v_smfmac_f32_32x32x32_bf16 v[144:159], v[136:139], v[192:199], v18
    s_add_u32 m0, s80, 32768
    s_xor_b32 s22, s16, 917504
    buffer_load_dwordx4 v44, s[56:59], s22 offen  lds
    v_exp_f32 v203, v203
    v_exp_f32 v204, v204
    v_exp_f32 v205, v205
    v_exp_f32 v206, v206
    v_exp_f32 v207, v207
    v_exp_f32 v208, v208
    v_exp_f32 v209, v209
    v_smfmac_f32_32x32x32_bf16 v[144:159], v[140:143], v[200:207], v18
    s_mov_b64 exec, 1
    buffer_load_dword v57, v4, s[52:55], s34 offen sc1
    s_mov_b64 exec, -1
    v_exp_f32 v210, v210
    v_exp_f32 v211, v211
    v_exp_f32 v212, v212
    s_waitcnt lgkmcnt(0)
    v_mfma_f32_32x32x16_bf16 v[192:207], v[184:187], v[176:179], v[224:239]
    s_add_u32 m0, s80, 40960
    s_xor_b32 s22, s16, 983040
    buffer_load_dwordx4 v44, s[56:59], s22 offen  lds
    v_exp_f32 v213, v213
    v_exp_f32 v214, v214
    v_exp_f32 v215, v215
    v_exp_f32 v216, v216
    v_exp_f32 v217, v217
    v_exp_f32 v218, v218
    v_smfmac_f32_32x32x32_bf16 v[160:175], v[136:139], v[208:215], v18
    v_exp_f32 v219, v219
    v_exp_f32 v220, v220
    v_exp_f32 v221, v221
    v_exp_f32 v222, v222
    v_exp_f32 v223, v223
    v_exp_f32 v192, v192
    v_exp_f32 v193, v193
    v_smfmac_f32_32x32x32_bf16 v[160:175], v[140:143], v[216:223], v18
    s_mov_b64 exec, s[84:85]
    ds_read_b128 v[136:139], v43 offset:50176
    ds_read_b128 v[140:143], v43 offset:50688
    s_mov_b64 exec, -1
    v_exp_f32 v194, v194
    v_exp_f32 v195, v195
    v_exp_f32 v196, v196
    v_mfma_f32_32x32x16_bf16 v[208:223], v[184:187], v[180:183], v[240:255]
    ds_read_b128 v[188:191], v42 offset:50176
    v_exp_f32 v197, v197
    v_exp_f32 v198, v198
    v_exp_f32 v199, v199
    v_exp_f32 v200, v200
    v_exp_f32 v201, v201
    v_exp_f32 v202, v202
    v_smfmac_f32_32x32x32_bf16 v[144:159], v[128:131], v[192:199], v18
    s_add_u32 m0, s80, 131072
    s_xor_b32 s22, s0, 262144
    buffer_load_dwordx4 v44, s[60:63], s22 offen  lds
    v_exp_f32 v203, v203
    v_exp_f32 v204, v204
    v_exp_f32 v205, v205
    v_exp_f32 v206, v206
    v_exp_f32 v207, v207
    v_exp_f32 v208, v208
    v_exp_f32 v209, v209
    v_smfmac_f32_32x32x32_bf16 v[144:159], v[132:135], v[200:207], v18
    v_exp_f32 v210, v210
    v_exp_f32 v211, v211
    v_exp_f32 v212, v212
    s_waitcnt lgkmcnt(0)
    v_mfma_f32_32x32x16_bf16 v[192:207], v[188:191], v[176:179], v[224:239]
    v_exp_f32 v213, v213
    v_exp_f32 v214, v214
    v_exp_f32 v215, v215
    v_exp_f32 v216, v216
    v_exp_f32 v217, v217
    v_exp_f32 v218, v218
    v_smfmac_f32_32x32x32_bf16 v[160:175], v[128:131], v[208:215], v18
    v_exp_f32 v219, v219
    v_exp_f32 v220, v220
    v_exp_f32 v221, v221
    v_exp_f32 v222, v222
    v_exp_f32 v223, v223
    s_setprio 2
    v_exp_f32 v192, v192
    v_exp_f32 v193, v193
    v_smfmac_f32_32x32x32_bf16 v[160:175], v[132:135], v[216:223], v18
    s_mov_b64 exec, s[84:85]
    ds_read_b128 v[128:131], v43 offset:51200
    ds_read_b128 v[132:135], v43 offset:51712
    s_mov_b64 exec, -1
    v_exp_f32 v194, v194
    v_exp_f32 v195, v195
    v_exp_f32 v196, v196
    v_mfma_f32_32x32x16_bf16 v[208:223], v[188:191], v[180:183], v[240:255]
    ds_read_b128 v[184:187], v42 offset:51200
    v_exp_f32 v197, v197
    v_exp_f32 v198, v198
    v_exp_f32 v199, v199
    v_exp_f32 v200, v200
    v_exp_f32 v201, v201
    v_exp_f32 v202, v202
    v_smfmac_f32_32x32x32_bf16 v[144:159], v[136:139], v[192:199], v18
    s_mov_b32 s22, 81920
    buffer_load_dwordx4 v[104:107], v19, s[52:55], s22 offen sc1
    v_exp_f32 v203, v203
    v_exp_f32 v204, v204
    v_exp_f32 v205, v205
    v_exp_f32 v206, v206
    v_exp_f32 v207, v207
    v_exp_f32 v208, v208
    v_exp_f32 v209, v209
    v_smfmac_f32_32x32x32_bf16 v[144:159], v[140:143], v[200:207], v18
    buffer_load_dwordx4 v[108:111], v19, s[52:55], s101 offen sc1
    v_exp_f32 v210, v210
    v_exp_f32 v211, v211
    v_exp_f32 v212, v212
    s_waitcnt lgkmcnt(0)
    v_mfma_f32_32x32x16_bf16 v[192:207], v[184:187], v[176:179], v[224:239]
    v_exp_f32 v213, v213
    v_exp_f32 v214, v214
    v_exp_f32 v215, v215
    v_exp_f32 v216, v216
    v_exp_f32 v217, v217
    v_exp_f32 v218, v218
    v_smfmac_f32_32x32x32_bf16 v[160:175], v[136:139], v[208:215], v18
    v_exp_f32 v219, v219
    v_exp_f32 v220, v220
    v_exp_f32 v221, v221
    v_exp_f32 v222, v222
    v_exp_f32 v223, v223
    s_setprio 1
    v_exp_f32 v192, v192
    v_exp_f32 v193, v193
    v_smfmac_f32_32x32x32_bf16 v[160:175], v[140:143], v[216:223], v18
    s_mov_b64 exec, s[84:85]
    ds_read_b128 v[136:139], v43 offset:52224
    ds_read_b128 v[140:143], v43 offset:52736
    s_mov_b64 exec, -1
    v_exp_f32 v194, v194
    v_exp_f32 v195, v195
    v_exp_f32 v196, v196
    v_mfma_f32_32x32x16_bf16 v[208:223], v[184:187], v[180:183], v[240:255]
    ds_read_b128 v[188:191], v42 offset:52224
    v_exp_f32 v197, v197
    v_exp_f32 v198, v198
    v_exp_f32 v199, v199
    v_exp_f32 v200, v200
    v_exp_f32 v201, v201
    v_exp_f32 v202, v202
    v_smfmac_f32_32x32x32_bf16 v[144:159], v[128:131], v[192:199], v18
L_page5:
    s_cbranch_execz L_it2
    v_exp_f32 v203, v203
    v_exp_f32 v204, v204
    v_exp_f32 v205, v205
    v_exp_f32 v206, v206
    v_exp_f32 v207, v207
    s_setprio 0
    v_exp_f32 v208, v208
    v_exp_f32 v209, v209
    v_smfmac_f32_32x32x32_bf16 v[144:159], v[132:135], v[200:207], v18
    v_exp_f32 v210, v210
    v_exp_f32 v211, v211
    v_exp_f32 v212, v212
    s_waitcnt lgkmcnt(0)
    v_mfma_f32_32x32x16_bf16 v[192:207], v[188:191], v[176:179], v[224:239]
    v_exp_f32 v213, v213
    v_exp_f32 v214, v214
    v_exp_f32 v215, v215
    v_exp_f32 v216, v216
    v_exp_f32 v217, v217
    v_exp_f32 v218, v218
    v_smfmac_f32_32x32x32_bf16 v[160:175], v[128:131], v[208:215], v18
    v_exp_f32 v219, v219
    v_exp_f32 v220, v220
    v_exp_f32 v221, v221
    v_exp_f32 v222, v222
    v_exp_f32 v223, v223
    s_barrier
    s_setprio 1
    v_exp_f32 v192, v192
    v_exp_f32 v193, v193
    v_smfmac_f32_32x32x32_bf16 v[160:175], v[132:135], v[216:223], v18
    v_exp_f32 v194, v194
    v_exp_f32 v195, v195
    v_exp_f32 v196, v196
    v_mfma_f32_32x32x16_bf16 v[208:223], v[188:191], v[180:183], v[240:255]
    v_exp_f32 v197, v197
    v_exp_f32 v198, v198
    v_exp_f32 v199, v199
    v_exp_f32 v200, v200
    v_exp_f32 v201, v201
    v_exp_f32 v202, v202
    v_smfmac_f32_32x32x32_bf16 v[144:159], v[136:139], v[192:199], v18
    v_exp_f32 v203, v203
    v_exp_f32 v204, v204
    v_exp_f32 v205, v205
    v_exp_f32 v206, v206
    v_exp_f32 v207, v207
    s_setprio 0
    v_exp_f32 v208, v208
    v_exp_f32 v209, v209
    v_smfmac_f32_32x32x32_bf16 v[144:159], v[140:143], v[200:207], v18
    v_exp_f32 v210, v210
    v_exp_f32 v211, v211
    v_exp_f32 v212, v212
    v_exp_f32 v213, v213
    v_exp_f32 v214, v214
    v_exp_f32 v215, v215
    v_exp_f32 v216, v216
    v_exp_f32 v217, v217
    v_exp_f32 v218, v218
    v_smfmac_f32_32x32x32_bf16 v[160:175], v[136:139], v[208:215], v18
    v_xor_b32 v58, 1024, v20
    v_exp_f32 v219, v219
    v_exp_f32 v220, v220
    v_exp_f32 v221, v221
    ds_write_b32 v58, v152 offset:16384
    ds_write_b128 v58, v[144:147]
    v_exp_f32 v222, v222
    ds_write_b128 v58, v[148:151] offset:8192
    v_exp_f32 v223, v223
    s_nop 1
    v_smfmac_f32_32x32x32_bf16 v[160:175], v[140:143], v[216:223], v18
    s_setprio 0
    v_mov_b32 v59, 0x08800000
    s_waitcnt vmcnt(2) lgkmcnt(0)
    s_barrier
    ds_read_b32 v232, v20 offset:16384
    ds_read_b128 v[224:227], v20
    ds_read_b128 v[228:231], v20 offset:8192
    s_waitcnt lgkmcnt(2)
    s_nop 3
    v_add_f32 v168, v168, v232
    v_rcp_f32 v8, v168
    s_waitcnt lgkmcnt(1)
    v_pk_add_f32 v[160:161], v[160:161], v[224:225]
    v_pk_add_f32 v[162:163], v[162:163], v[226:227]
    v_pk_mul_f32 v[224:225], v[160:161], v[8:9] op_sel_hi:[1,0]
    v_pk_mul_f32 v[226:227], v[162:163], v[8:9] op_sel_hi:[1,0]
    v_cvt_pk_bf16_f32 v236, v224, v225
    v_cvt_pk_bf16_f32 v237, v226, v227
    s_waitcnt lgkmcnt(0)
    v_pk_add_f32 v[164:165], v[164:165], v[228:229]
    v_pk_add_f32 v[166:167], v[166:167], v[230:231]
    v_pk_mul_f32 v[228:229], v[164:165], v[8:9] op_sel_hi:[1,0]
    v_pk_mul_f32 v[230:231], v[166:167], v[8:9] op_sel_hi:[1,0]
    v_cvt_pk_bf16_f32 v238, v228, v229
    v_cvt_pk_bf16_f32 v239, v230, v231
    buffer_store_dwordx4 v[236:239], v4, s[52:55], s98 offen sc1
    v_maximum3_f32 v224, |v160|, |v161|, |v162|
    v_maximum3_f32 v225, |v163|, |v164|, |v165|
    v_maximum3_f32 v226, |v166|, |v167|, |v167|
    v_sub_u32 v58, v168, v59
    v_maximum3_f32 v224, v224, v225, v226
    v_cmp_lt_u32 vcc, 0x73000000, v58
    v_subrev_u32 v225, 1, v224
    s_mov_b64 s[12:13], vcc
    v_cmp_le_u32 vcc, 0x7f800000, v224
    s_or_b64 s[12:13], s[12:13], vcc
    v_cmp_lt_u32 vcc, v225, v59
    s_or_b64 vcc, vcc, s[12:13]
    s_cbranch_scc1 L_fallback
L_att_fin:
    v_add_u32 v52, 98304, v52
    ds_read_b64_tr_b16 v[192:193], v52 offset:0
    ds_read_b64_tr_b16 v[194:195], v52 offset:1024
    v_add_u32 v53, 98304, v53
    ds_read_b64_tr_b16 v[196:197], v53 offset:0
    ds_read_b64_tr_b16 v[198:199], v53 offset:1024
    ds_read_b64_tr_b16 v[200:201], v52 offset:8192
    ds_read_b64_tr_b16 v[202:203], v52 offset:9216
    ds_read_b64_tr_b16 v[204:205], v53 offset:8192
    ds_read_b64_tr_b16 v[206:207], v53 offset:9216
    s_waitcnt lgkmcnt(6)
    v_mfma_f32_32x32x16_bf16 v[64:79], v[48:51], v[192:195], v[64:79]
    v_lshl_add_u32 v40, v1, 2, s92
    v_lshlrev_b32 v40, 7, v40
    s_lshl_b32 s92, s92, 10
    s_add_u32 s92, s92, 5242880
    ds_read_b64_tr_b16 v[192:193], v52 offset:16384
    ds_read_b64_tr_b16 v[194:195], v52 offset:17408
    s_waitcnt lgkmcnt(6)
    v_mfma_f32_32x32x16_bf16 v[80:95], v[48:51], v[196:199], v[80:95]
    v_add_u32 v19, s92, v4
    s_mul_i32 s9, s5, 1280
    v_and_b32 v9, 3, v0
    v_lshl_add_u32 v9, v9, 5, s9
    ds_read_b64_tr_b16 v[196:197], v53 offset:16384
    ds_read_b64_tr_b16 v[198:199], v53 offset:17408
    s_waitcnt lgkmcnt(6)
    v_mfma_f32_32x32x16_bf16 v[64:79], v[60:63], v[200:203], v[64:79]
    s_lshl_b32 s9, s9, 2
    v_bfe_i32 v248, v0, 2, 1
    v_and_b32 v248, 40960, v248
    v_add_u32 v9, v9, v248
    ds_read_b64_tr_b16 v[200:201], v52 offset:24576
    ds_read_b64_tr_b16 v[202:203], v52 offset:25600
    s_waitcnt lgkmcnt(6)
    v_mfma_f32_32x32x16_bf16 v[80:95], v[60:63], v[204:207], v[80:95]
    v_bfe_i32 v248, v0, 3, 1
    v_and_b32 v248, 272, v248
    v_add_u32 v9, v9, v248
    v_bfe_i32 v248, v0, 4, 1
    ds_read_b64_tr_b16 v[204:205], v53 offset:24576
    ds_read_b64_tr_b16 v[206:207], v53 offset:25600
    s_waitcnt lgkmcnt(6)
    v_mfma_f32_32x32x16_bf16 v[64:79], v[112:115], v[192:195], v[64:79]
    v_and_b32 v248, 640, v248
    v_add_u32 v9, v9, v248
    v_bfe_i32 v248, v0, 5, 1
    v_and_b32 v248, 128, v248
    s_waitcnt vmcnt(0)
    s_mov_b64 exec, 1
    buffer_store_dword v2, v4, s[52:55], s34 offen sc1
    s_mov_b64 exec, -1
    v_and_b32 v132, 1023, v46
    buffer_load_dwordx4 v[128:131], v46, s[36:39], 0 offen
    buffer_load_dwordx4 v[132:135], v132, s[68:71], 0 offen
    v_add_u32 v52, 4294868992, v52
    ds_read_b64_tr_b16 v[192:193], v52 offset:0
    ds_read_b64_tr_b16 v[194:195], v52 offset:1024
    s_waitcnt lgkmcnt(6)
    v_mfma_f32_32x32x16_bf16 v[80:95], v[112:115], v[196:199], v[80:95]
    v_add_u32 v9, v9, v248
    v_add_u32 v53, 4294868992, v53
    ds_read_b64_tr_b16 v[196:197], v53 offset:0
    ds_read_b64_tr_b16 v[198:199], v53 offset:1024
    s_waitcnt lgkmcnt(6)
    v_mfma_f32_32x32x16_bf16 v[64:79], v[116:119], v[200:203], v[64:79]
    ds_read_b64_tr_b16 v[200:201], v52 offset:8192
    ds_read_b64_tr_b16 v[202:203], v52 offset:9216
    s_waitcnt lgkmcnt(6)
    v_mfma_f32_32x32x16_bf16 v[80:95], v[116:119], v[204:207], v[80:95]
    s_barrier
    s_add_u32 m0, s80, 98304
    s_xor_b32 s22, s0, 0
    buffer_load_dwordx4 v44, s[60:63], s22 offen  lds
    ds_read_b64_tr_b16 v[204:205], v53 offset:8192
    ds_read_b64_tr_b16 v[206:207], v53 offset:9216
    s_waitcnt lgkmcnt(6)
    v_mfma_f32_32x32x16_bf16 v[64:79], v[120:123], v[192:195], v[64:79]
    ds_read_b64_tr_b16 v[192:193], v52 offset:16384
    ds_read_b64_tr_b16 v[194:195], v52 offset:17408
    s_waitcnt lgkmcnt(6)
    v_mfma_f32_32x32x16_bf16 v[80:95], v[120:123], v[196:199], v[80:95]
    s_add_u32 m0, s80, 106496
    s_xor_b32 s22, s0, 65536
    buffer_load_dwordx4 v44, s[60:63], s22 offen  lds
    ds_read_b64_tr_b16 v[196:197], v53 offset:16384
    ds_read_b64_tr_b16 v[198:199], v53 offset:17408
    s_waitcnt lgkmcnt(6)
    v_mfma_f32_32x32x16_bf16 v[64:79], v[124:127], v[200:203], v[64:79]
    ds_read_b64_tr_b16 v[200:201], v52 offset:24576
    ds_read_b64_tr_b16 v[202:203], v52 offset:25600
    s_waitcnt lgkmcnt(6)
    v_mfma_f32_32x32x16_bf16 v[80:95], v[124:127], v[204:207], v[80:95]
    s_add_u32 m0, s80, 114688
    s_xor_b32 s22, s0, 131072
    buffer_load_dwordx4 v44, s[60:63], s22 offen  lds
    ds_read_b64_tr_b16 v[204:205], v53 offset:24576
    ds_read_b64_tr_b16 v[206:207], v53 offset:25600
    s_waitcnt lgkmcnt(6)
    v_mfma_f32_32x32x16_bf16 v[64:79], v[10:13], v[192:195], v[64:79]
    ds_read_b64_tr_b16 v[192:193], v52 offset:32768
    ds_read_b64_tr_b16 v[194:195], v52 offset:33792
    s_waitcnt lgkmcnt(6)
    v_mfma_f32_32x32x16_bf16 v[80:95], v[10:13], v[196:199], v[80:95]
    s_add_u32 m0, s80, 122880
    s_xor_b32 s22, s0, 196608
    buffer_load_dwordx4 v44, s[60:63], s22 offen  lds
    ds_read_b64_tr_b16 v[196:197], v53 offset:32768
    ds_read_b64_tr_b16 v[198:199], v53 offset:33792
    s_waitcnt lgkmcnt(6)
    v_mfma_f32_32x32x16_bf16 v[64:79], v[14:17], v[200:203], v[64:79]
    ds_read_b64_tr_b16 v[200:201], v52 offset:40960
    ds_read_b64_tr_b16 v[202:203], v52 offset:41984
    s_waitcnt lgkmcnt(6)
    v_mfma_f32_32x32x16_bf16 v[80:95], v[14:17], v[204:207], v[80:95]
    s_add_u32 m0, s80, 139264
    s_xor_b32 s22, s0, 327680
    buffer_load_dwordx4 v44, s[60:63], s22 offen  lds
    ds_read_b64_tr_b16 v[204:205], v53 offset:40960
    ds_read_b64_tr_b16 v[206:207], v53 offset:41984
    s_waitcnt lgkmcnt(6)
    v_mfma_f32_32x32x16_bf16 v[64:79], v[22:25], v[192:195], v[64:79]
    ds_read_b64_tr_b16 v[192:193], v52 offset:49152
    ds_read_b64_tr_b16 v[194:195], v52 offset:50176
    s_waitcnt lgkmcnt(6)
    v_mfma_f32_32x32x16_bf16 v[80:95], v[22:25], v[196:199], v[80:95]
    s_add_u32 m0, s80, 147456
    s_xor_b32 s22, s0, 393216
    buffer_load_dwordx4 v44, s[60:63], s22 offen  lds
    ds_read_b64_tr_b16 v[196:197], v53 offset:49152
    ds_read_b64_tr_b16 v[198:199], v53 offset:50176
    s_waitcnt lgkmcnt(6)
    v_mfma_f32_32x32x16_bf16 v[64:79], v[26:29], v[200:203], v[64:79]
    s_barrier
    s_mov_b32 s22, 786432
    s_mov_b64 exec, 255
    buffer_load_dword v54, v40, s[52:55], s22 offen sc1
    s_mov_b64 exec, -1
    s_waitcnt vmcnt(7)
    ds_read_b64_tr_b16 v[200:201], v52 offset:57344
    ds_read_b64_tr_b16 v[202:203], v52 offset:58368
    s_waitcnt lgkmcnt(6)
    v_mfma_f32_32x32x16_bf16 v[80:95], v[26:29], v[204:207], v[80:95]
    v_add_u32 v52, 131072, v52
    ds_read_b64_tr_b16 v[208:209], v52 offset:0
    ds_read_b64_tr_b16 v[210:211], v52 offset:1024
    v_lshlrev_b32 v240, 16, v128
    v_and_b32 v241, s15, v128
    v_lshlrev_b32 v248, 16, v132
    v_and_b32 v249, s15, v132
    s_add_u32 m0, s80, 155648
    s_xor_b32 s22, s0, 458752
    buffer_load_dwordx4 v44, s[60:63], s22 offen  lds
    ds_read_b64_tr_b16 v[204:205], v53 offset:57344
    ds_read_b64_tr_b16 v[206:207], v53 offset:58368
    s_waitcnt lgkmcnt(8)
    v_mfma_f32_32x32x16_bf16 v[64:79], v[30:33], v[192:195], v[64:79]
    v_add_u32 v53, 131072, v53
    ds_read_b64_tr_b16 v[212:213], v53 offset:0
    ds_read_b64_tr_b16 v[214:215], v53 offset:1024
    v_add_f32 v240, v240, v248
    v_add_f32 v241, v241, v249
    v_lshlrev_b32 v242, 16, v129
    v_and_b32 v243, s15, v129
    v_add_u32 v52, 4294837264, v52
    ds_read_b64_tr_b16 v[192:193], v52 offset:64496
    ds_read_b64_tr_b16 v[194:195], v52 offset:65520
    s_waitcnt lgkmcnt(10)
    v_mfma_f32_32x32x16_bf16 v[80:95], v[30:33], v[196:199], v[80:95]
    v_lshlrev_b32 v248, 16, v133
    v_and_b32 v249, s15, v133
    v_add_f32 v242, v242, v248
    v_add_f32 v243, v243, v249
    v_add_u32 v53, 4294837264, v53
    ds_read_b64_tr_b16 v[196:197], v53 offset:64496
    ds_read_b64_tr_b16 v[198:199], v53 offset:65520
    s_waitcnt lgkmcnt(10)
    v_mfma_f32_32x32x16_bf16 v[64:79], v[34:37], v[200:203], v[64:79]
    v_lshlrev_b32 v244, 16, v130
    v_and_b32 v245, s15, v130
    v_lshlrev_b32 v248, 16, v134
    v_and_b32 v249, s15, v134
    v_add_u32 v52, 72688, v52
    ds_read_b64_tr_b16 v[200:201], v52 offset:0
    ds_read_b64_tr_b16 v[202:203], v52 offset:1024
    s_waitcnt lgkmcnt(8)
    v_mfma_f32_32x32x16_bf16 v[80:95], v[34:37], v[204:207], v[80:95]
    v_add_f32 v244, v244, v248
    v_add_f32 v245, v245, v249
    v_lshlrev_b32 v246, 16, v131
    v_and_b32 v247, s15, v131
    v_add_u32 v53, 72688, v53
    ds_read_b64_tr_b16 v[204:205], v53 offset:0
    ds_read_b64_tr_b16 v[206:207], v53 offset:1024
    s_waitcnt lgkmcnt(6)
    v_mfma_f32_32x32x16_bf16 v[64:79], v[96:99], v[192:195], v[64:79]
    v_lshlrev_b32 v248, 16, v135
    v_and_b32 v249, s15, v135
    v_add_f32 v246, v246, v248
    v_add_f32 v247, v247, v249
    ds_read_b64_tr_b16 v[192:193], v52 offset:8192
    ds_read_b64_tr_b16 v[194:195], v52 offset:9216
    s_waitcnt lgkmcnt(6)
    v_mfma_f32_32x32x16_bf16 v[80:95], v[96:99], v[196:199], v[80:95]
    ds_read_b64_tr_b16 v[196:197], v53 offset:8192
    ds_read_b64_tr_b16 v[198:199], v53 offset:9216
    s_waitcnt lgkmcnt(6)
    v_mfma_f32_32x32x16_bf16 v[64:79], v[100:103], v[200:203], v[64:79]
    ds_read_b64_tr_b16 v[200:201], v52 offset:16384
    ds_read_b64_tr_b16 v[202:203], v52 offset:17408
    s_waitcnt lgkmcnt(6)
    v_mfma_f32_32x32x16_bf16 v[80:95], v[100:103], v[204:207], v[80:95]
    ds_read_b64_tr_b16 v[204:205], v53 offset:16384
    ds_read_b64_tr_b16 v[206:207], v53 offset:17408
    s_waitcnt lgkmcnt(6)
    v_mfma_f32_32x32x16_bf16 v[64:79], v[104:107], v[192:195], v[64:79]
    s_waitcnt lgkmcnt(4)
    v_mfma_f32_32x32x16_bf16 v[80:95], v[104:107], v[196:199], v[80:95]
    s_waitcnt lgkmcnt(2)
    v_mfma_f32_32x32x16_bf16 v[64:79], v[108:111], v[200:203], v[64:79]
    s_waitcnt lgkmcnt(0)
    v_mfma_f32_32x32x16_bf16 v[80:95], v[108:111], v[204:207], v[80:95]
    s_mov_b32 m0, s9
    s_waitcnt vmcnt(1)
    v_cmp_ne_u32 vcc, v54, v2
    s_and_b32 s22, vcc_lo, 255
    s_cbranch_scc1 L_spin_21
L_back_22:
    s_xor_b32 s22, s1, 0
    buffer_load_dwordx4 v[128:131], v19, s[52:55], s22 offen sc1
    s_xor_b32 s22, s1, 4096
    buffer_load_dwordx4 v[132:135], v19, s[52:55], s22 offen sc1
    s_waitcnt vmcnt(2)
    s_barrier
    ds_read_b64_tr_b16 v[160:161], v52 offset:24576
    ds_read_b64_tr_b16 v[162:163], v52 offset:25600
    ds_read_b64_tr_b16 v[164:165], v53 offset:24576
    ds_read_b64_tr_b16 v[166:167], v53 offset:25600
    ds_read_b64_tr_b16 v[168:169], v52 offset:32768
    ds_read_b64_tr_b16 v[170:171], v52 offset:33792
    ds_read_b64_tr_b16 v[172:173], v53 offset:32768
    ds_read_b64_tr_b16 v[174:175], v53 offset:33792
    s_xor_b32 s22, s1, 8192
    buffer_load_dwordx4 v[136:139], v19, s[52:55], s22 offen sc1
    ds_read_b64_tr_b16 v[176:177], v52 offset:40960
    ds_read_b64_tr_b16 v[178:179], v52 offset:41984
    ds_read_b64_tr_b16 v[180:181], v53 offset:40960
    ds_read_b64_tr_b16 v[182:183], v53 offset:41984
    ds_read_b64_tr_b16 v[184:185], v52 offset:49152
    ds_read_b64_tr_b16 v[186:187], v52 offset:50176
    ds_read_b64_tr_b16 v[188:189], v53 offset:49152
    ds_read_b64_tr_b16 v[190:191], v53 offset:50176
    s_xor_b32 s22, s1, 12288
    buffer_load_dwordx4 v[140:143], v19, s[52:55], s22 offen sc1
    v_add_u32 v52, 65536, v52
    ds_read_b64_tr_b16 v[216:217], v52 offset:0
    ds_read_b64_tr_b16 v[218:219], v52 offset:1024
    v_add_u32 v53, 65536, v53
    ds_read_b64_tr_b16 v[220:221], v53 offset:0
    ds_read_b64_tr_b16 v[222:223], v53 offset:1024
    ds_read_b64_tr_b16 v[224:225], v52 offset:8192
    ds_read_b64_tr_b16 v[226:227], v52 offset:9216
    ds_read_b64_tr_b16 v[228:229], v53 offset:8192
    ds_read_b64_tr_b16 v[230:231], v53 offset:9216
    s_xor_b32 s22, s1, 16384
    buffer_load_dwordx4 v[144:147], v19, s[52:55], s22 offen sc1
    ds_read_b64_tr_b16 v[232:233], v52 offset:16384
    ds_read_b64_tr_b16 v[234:235], v52 offset:17408
    ds_read_b64_tr_b16 v[236:237], v53 offset:16384
    ds_read_b64_tr_b16 v[238:239], v53 offset:17408
    s_xor_b32 s22, s1, 20480
    buffer_load_dwordx4 v[148:151], v19, s[52:55], s22 offen sc1
    s_xor_b32 s22, s1, 24576
    buffer_load_dwordx4 v[152:155], v19, s[52:55], s22 offen sc1
    s_xor_b32 s22, s1, 28672
    buffer_load_dwordx4 v[156:159], v19, s[52:55], s22 offen sc1
    buffer_store_dword v2, v5, s[52:55], s100 offen sc1
    s_waitcnt vmcnt(8) lgkmcnt(0)
    v_mfma_f32_32x32x16_bf16 v[64:79], v[128:131], v[160:163], v[64:79]
    v_mfma_f32_32x32x16_bf16 v[80:95], v[128:131], v[164:167], v[80:95]
    s_waitcnt vmcnt(7)
    v_mfma_f32_32x32x16_bf16 v[64:79], v[132:135], v[168:171], v[64:79]
    v_mfma_f32_32x32x16_bf16 v[80:95], v[132:135], v[172:175], v[80:95]
    s_waitcnt vmcnt(6)
    v_mfma_f32_32x32x16_bf16 v[64:79], v[136:139], v[176:179], v[64:79]
    v_mfma_f32_32x32x16_bf16 v[80:95], v[136:139], v[180:183], v[80:95]
    s_waitcnt vmcnt(5)
    v_mfma_f32_32x32x16_bf16 v[64:79], v[140:143], v[184:187], v[64:79]
    v_mfma_f32_32x32x16_bf16 v[80:95], v[140:143], v[188:191], v[80:95]
    s_waitcnt vmcnt(4)
    v_mfma_f32_32x32x16_bf16 v[64:79], v[144:147], v[208:211], v[64:79]
    v_mfma_f32_32x32x16_bf16 v[80:95], v[144:147], v[212:215], v[80:95]
    s_waitcnt vmcnt(3)
    v_mfma_f32_32x32x16_bf16 v[64:79], v[148:151], v[216:219], v[64:79]
    v_mfma_f32_32x32x16_bf16 v[80:95], v[148:151], v[220:223], v[80:95]
    s_waitcnt vmcnt(2)
    v_mfma_f32_32x32x16_bf16 v[64:79], v[152:155], v[224:227], v[64:79]
    v_mfma_f32_32x32x16_bf16 v[80:95], v[152:155], v[228:231], v[80:95]
    s_waitcnt vmcnt(1)
    v_mfma_f32_32x32x16_bf16 v[64:79], v[156:159], v[232:235], v[64:79]
    v_mfma_f32_32x32x16_bf16 v[80:95], v[156:159], v[236:239], v[80:95]
    s_nop 10
    ds_write_addtid_b32 v64 offset:0
    ds_write_addtid_b32 v65 offset:272
    ds_write_addtid_b32 v66 offset:640
    ds_write_addtid_b32 v67 offset:912
    ds_write_addtid_b32 v68 offset:1280
    ds_write_addtid_b32 v69 offset:1552
    ds_write_addtid_b32 v70 offset:1920
    ds_write_addtid_b32 v71 offset:2192
    ds_write_addtid_b32 v72 offset:2560
    ds_write_addtid_b32 v73 offset:2832
    ds_write_addtid_b32 v74 offset:3200
    ds_write_addtid_b32 v75 offset:3472
    ds_write_addtid_b32 v76 offset:3840
    ds_write_addtid_b32 v77 offset:4112
    ds_write_addtid_b32 v78 offset:4480
    ds_write_addtid_b32 v79 offset:4752
    ds_write_addtid_b32 v80 offset:40960
    ds_write_addtid_b32 v81 offset:41232
    ds_write_addtid_b32 v82 offset:41600
    ds_write_addtid_b32 v83 offset:41872
    ds_write_addtid_b32 v84 offset:42240
    ds_write_addtid_b32 v85 offset:42512
    ds_write_addtid_b32 v86 offset:42880
    ds_write_addtid_b32 v87 offset:43152
    ds_write_addtid_b32 v88 offset:43520
    ds_write_addtid_b32 v89 offset:43792
    ds_write_addtid_b32 v90 offset:44160
    ds_write_addtid_b32 v91 offset:44432
    ds_write_addtid_b32 v92 offset:44800
    ds_write_addtid_b32 v93 offset:45072
    ds_write_addtid_b32 v94 offset:45440
    ds_write_addtid_b32 v95 offset:45712
    s_waitcnt lgkmcnt(0)
    s_barrier
    ds_read_b128 v[128:131], v9 offset:0
    ds_read_b128 v[132:135], v9 offset:16
    ds_read_b128 v[136:139], v9 offset:10240
    ds_read_b128 v[140:143], v9 offset:10256
    ds_read_b128 v[144:147], v9 offset:20480
    ds_read_b128 v[148:151], v9 offset:20496
    ds_read_b128 v[152:155], v9 offset:30720
    ds_read_b128 v[156:159], v9 offset:30736
    s_waitcnt lgkmcnt(6)
    v_pk_add_f32 v[240:241], v[240:241], v[128:129]
    v_pk_add_f32 v[242:243], v[242:243], v[130:131]
    v_pk_add_f32 v[244:245], v[244:245], v[132:133]
    v_pk_add_f32 v[246:247], v[246:247], v[134:135]
    s_waitcnt lgkmcnt(4)
    v_pk_add_f32 v[240:241], v[240:241], v[136:137]
    v_pk_add_f32 v[242:243], v[242:243], v[138:139]
    v_pk_add_f32 v[244:245], v[244:245], v[140:141]
    v_pk_add_f32 v[246:247], v[246:247], v[142:143]
    s_waitcnt lgkmcnt(2)
    v_pk_add_f32 v[240:241], v[240:241], v[144:145]
    v_pk_add_f32 v[242:243], v[242:243], v[146:147]
    v_pk_add_f32 v[244:245], v[244:245], v[148:149]
    v_pk_add_f32 v[246:247], v[246:247], v[150:151]
    s_waitcnt lgkmcnt(0)
    v_pk_add_f32 v[240:241], v[240:241], v[152:153]
    v_pk_add_f32 v[242:243], v[242:243], v[154:155]
    v_pk_add_f32 v[244:245], v[244:245], v[156:157]
    v_pk_add_f32 v[246:247], v[246:247], v[158:159]
    v_cvt_pk_bf16_f32 v56, v240, v241
    v_cvt_pk_bf16_f32 v57, v242, v243
    v_cvt_pk_bf16_f32 v58, v244, v245
    v_cvt_pk_bf16_f32 v59, v246, v247
    buffer_store_dwordx4 v[56:59], v46, s[72:75], 0 offen sc1
L_finish:
L_exit:
    s_endpgm
L_spin_1:
    s_mov_b32 s23, 69632
    s_mov_b32 s93, 200000
L_lp_3:
    s_sleep 4
    buffer_load_dwordx4 v[56:59], v35, s[52:55], s23 offen sc1
    s_waitcnt vmcnt(0)
    v_cmp_ne_u32 vcc, v57, v2
    v_cmp_ne_u32 s[12:13], v59, v2
    s_or_b64 vcc, vcc, s[12:13]
    s_cbranch_scc0 L_back_2
    s_sub_u32 s93, s93, 1
    s_cbranch_scc0 L_lp_3
    s_branch L_back_2
L_spin_4:
    s_mov_b32 s23, 69632
    s_mov_b32 s93, 200000
L_lp_6:
    s_sleep 4
    buffer_load_dwordx4 v[56:59], v35, s[52:55], s23 offen sc1
    s_waitcnt vmcnt(0)
    v_cmp_ne_u32 vcc, v57, v2
    v_cmp_ne_u32 s[12:13], v59, v2
    s_or_b64 vcc, vcc, s[12:13]
    s_cbranch_scc0 L_back_5
    s_sub_u32 s93, s93, 1
    s_cbranch_scc0 L_lp_6
    s_branch L_back_5
L_spin_7:
    s_mov_b32 s23, 4096
    s_mov_b32 s93, 200000
L_lp_9:
    s_sleep 4
    s_mov_b64 exec, 255
    v_mov_b32 v54, 0
    buffer_load_dword v54, v39, s[52:55], s23 offen sc1
    s_mov_b64 exec, -1
    s_waitcnt vmcnt(0)
    v_cmp_ne_u32 vcc, v54, v2
    s_and_b32 s22, vcc_lo, 3
    s_cbranch_scc0 L_back_8
    s_sub_u32 s93, s93, 1
    s_cbranch_scc0 L_lp_9
    s_branch L_back_8
L_spin_12:
    s_mov_b32 s23, 4096
    s_mov_b32 s93, 200000
L_lp_14:
    s_sleep 4
    s_mov_b64 exec, 255
    v_mov_b32 v54, 0
    buffer_load_dword v54, v39, s[52:55], s23 offen sc1
    s_mov_b64 exec, -1
    s_waitcnt vmcnt(0)
    v_cmp_ne_u32 vcc, v54, v2
    s_and_b32 s22, vcc_lo, 4
    s_cbranch_scc0 L_back_13
    s_sub_u32 s93, s93, 1
    s_cbranch_scc0 L_lp_14
    s_branch L_back_13
L_spin_15:
    s_mov_b32 s23, 4096
    s_mov_b32 s93, 200000
L_lp_17:
    s_sleep 4
    s_mov_b64 exec, 255
    v_mov_b32 v54, 0
    buffer_load_dword v54, v39, s[52:55], s23 offen sc1
    s_mov_b64 exec, -1
    s_waitcnt vmcnt(0)
    v_cmp_ne_u32 vcc, v54, v2
    s_and_b32 s22, vcc_lo, 248
    s_cbranch_scc0 L_back_16
    s_sub_u32 s93, s93, 1
    s_cbranch_scc0 L_lp_17
    s_branch L_back_16
L_spin_18:
    s_mov_b32 s23, 36864
    s_mov_b32 s93, 200000
L_lp_20:
    s_sleep 4
    s_mov_b64 exec, s[32:33]
    v_mov_b32 v54, 0
    buffer_load_dword v54, v40, s[52:55], s23 offen sc1
    s_mov_b64 exec, -1
    s_waitcnt vmcnt(0)
    v_cmp_ne_u32 vcc, v54, v2
    s_and_b32 s22, vcc_lo, s32
    s_cbranch_scc0 L_back_19
    s_sub_u32 s93, s93, 1
    s_cbranch_scc0 L_lp_20
    s_branch L_back_19
L_spin_21:
    s_mov_b32 s23, 786432
    s_mov_b32 s93, 200000
L_lp_23:
    s_sleep 1
    s_mov_b64 exec, 255
    v_mov_b32 v54, 0
    buffer_load_dword v54, v40, s[52:55], s23 offen sc1
    s_mov_b64 exec, -1
    s_waitcnt vmcnt(0)
    v_cmp_ne_u32 vcc, v54, v2
    s_and_b32 s22, vcc_lo, 255
    s_cbranch_scc0 L_back_22
    s_sub_u32 s93, s93, 1
    s_cbranch_scc0 L_lp_23
    s_branch L_back_22
L_fallback:
    s_waitcnt vmcnt(0) lgkmcnt(0)
    s_lshl_b32 s9, s4, 14
    s_add_u32 s9, s9, 1048576
    s_lshl_b32 s10, s83, 12
    s_add_u32 s9, s9, s10
    v_and_b32 v42, 0x3ff, v42
    v_and_b32 v43, 0x3ff, v43
    v_add_u32 v43, 8192, v43
    v_mov_b32 v54, 0xff800000
    s_mov_b32 s93, 0
L_fb1:
    s_lshr_b32 s10, s93, 2
    s_lshl_b32 s10, s10, 18
    s_and_b32 s11, s93, 3
    s_lshl_b32 s11, s11, 10
    s_add_u32 s10, s10, s11
    s_add_u32 s10, s10, s9
    buffer_load_dwordx4 v[184:187], v42, s[52:55], s10 offen sc1
    s_waitcnt vmcnt(0)
    v_mfma_f32_32x32x16_bf16 v[192:207], v[184:187], v[180:183], 0
    s_nop 11
    v_max3_f32 v58, v192, v193, v194
    v_max3_f32 v59, v195, v196, v197
    v_max3_f32 v58, v58, v198, v199
    v_max3_f32 v59, v59, v200, v201
    v_max3_f32 v58, v58, v202, v203
    v_max3_f32 v59, v59, v204, v205
    v_max3_f32 v58, v58, v206, v207
    v_max_f32 v58, v58, v59
    v_max_f32 v54, v54, v58
    s_add_u32 s93, s93, 1
    s_cmp_lt_u32 s93, 64
    s_cbranch_scc1 L_fb1
    v_mov_b32 v59, v54
    s_nop 1
    v_permlane32_swap_b32 v54, v59
    v_max_f32 v58, v54, v59
    v_sub_f32 v240, 0, v58
    v_mov_b32 v160, 0
    v_sub_f32 v241, 0, v58
    v_mov_b32 v161, 0
    v_sub_f32 v242, 0, v58
    v_mov_b32 v162, 0
    v_sub_f32 v243, 0, v58
    v_mov_b32 v163, 0
    v_sub_f32 v244, 0, v58
    v_mov_b32 v164, 0
    v_sub_f32 v245, 0, v58
    v_mov_b32 v165, 0
    v_sub_f32 v246, 0, v58
    v_mov_b32 v166, 0
    v_sub_f32 v247, 0, v58
    v_mov_b32 v167, 0
    v_sub_f32 v248, 0, v58
    v_mov_b32 v168, 0
    v_sub_f32 v249, 0, v58
    v_mov_b32 v169, 0
    v_sub_f32 v250, 0, v58
    v_mov_b32 v170, 0
    v_sub_f32 v251, 0, v58
    v_mov_b32 v171, 0
    v_sub_f32 v252, 0, v58
    v_mov_b32 v172, 0
    v_sub_f32 v253, 0, v58
    v_mov_b32 v173, 0
    v_sub_f32 v254, 0, v58
    v_mov_b32 v174, 0
    v_sub_f32 v255, 0, v58
    v_mov_b32 v175, 0
    s_mov_b32 s93, 0
L_fb2:
    s_lshr_b32 s10, s93, 2
    s_lshl_b32 s10, s10, 18
    s_and_b32 s11, s93, 3
    s_lshl_b32 s11, s11, 10
    s_add_u32 s10, s10, s11
    s_add_u32 s10, s10, s9
    s_nop 7
    buffer_load_dwordx4 v[184:187], v42, s[52:55], s10 offen sc1
    s_mov_b64 exec, s[84:85]
    buffer_load_dwordx4 v[128:131], v43, s[52:55], s10 offen sc1
    buffer_load_dwordx4 v[132:135], v43, s[52:55], s10 offen offset:512 sc1
    s_mov_b64 exec, -1
    s_waitcnt vmcnt(0)
    v_mfma_f32_32x32x16_bf16 v[208:223], v[184:187], v[180:183], v[240:255]
    s_nop 11
    v_exp_f32 v208, v208
    v_exp_f32 v209, v209
    v_exp_f32 v210, v210
    v_exp_f32 v211, v211
    v_exp_f32 v212, v212
    v_exp_f32 v213, v213
    v_exp_f32 v214, v214
    v_exp_f32 v215, v215
    v_exp_f32 v216, v216
    v_exp_f32 v217, v217
    v_exp_f32 v218, v218
    v_exp_f32 v219, v219
    v_exp_f32 v220, v220
    v_exp_f32 v221, v221
    v_exp_f32 v222, v222
    v_exp_f32 v223, v223
    v_smfmac_f32_32x32x32_bf16 v[160:175], v[128:131], v[208:215], v18
    s_nop 0
    v_smfmac_f32_32x32x32_bf16 v[160:175], v[132:135], v[216:223], v18
    s_add_u32 s93, s93, 1
    s_cmp_lt_u32 s93, 64
    s_cbranch_scc1 L_fb2
    s_nop 15
    v_rcp_f32 v8, v168
    s_nop 0
    v_pk_mul_f32 v[224:225], v[160:161], v[8:9] op_sel_hi:[1,0]
    v_pk_mul_f32 v[226:227], v[162:163], v[8:9] op_sel_hi:[1,0]
    v_cvt_pk_bf16_f32 v236, v224, v225
    v_cvt_pk_bf16_f32 v237, v226, v227
    v_pk_mul_f32 v[228:229], v[164:165], v[8:9] op_sel_hi:[1,0]
    v_pk_mul_f32 v[230:231], v[166:167], v[8:9] op_sel_hi:[1,0]
    v_cvt_pk_bf16_f32 v238, v228, v229
    v_cvt_pk_bf16_f32 v239, v230, v231
    buffer_store_dwordx4 v[236:239], v4, s[52:55], s98 offen sc1
    s_branch L_att_fin
L_code_end:
.section .rodata,"a"
.p2align 6
.amdhsa_kernel parallel_sum__softmax_full_mha__dense_activation_squared_relu__prompt_kernel
  .amdhsa_next_free_vgpr 256
  .amdhsa_next_free_sgpr 102
  .amdhsa_accum_offset 256
  .amdhsa_group_segment_fixed_size 0
  .amdhsa_kernarg_size 88
  .amdhsa_user_sgpr_count 2
  .amdhsa_user_sgpr_kernarg_segment_ptr 1
  .amdhsa_system_sgpr_workgroup_id_x 1
.end_amdhsa_kernel
```
